```python
import torch

def _softmax(x, axis=-1):
    return torch.softmax(x, dim=axis)
def _gelu(x):
    return torch.nn.functional.gelu(x, approximate="tanh")
def _silu(x):
    return torch.nn.functional.silu(x)
def _sigmoid(x):
    return torch.sigmoid(x)
def _layernorm(x, axis=-1, eps=1e-5):
    m = x.mean(dim=axis, keepdim=True)
    v = x.var(dim=axis, keepdim=True, unbiased=False)
    return (x - m) / torch.sqrt(v + eps)
def _scatter_add(tgt, idx, src, axis=0):
    return tgt.clone().index_add_(axis, idx, src)
def _segment_sum(src, seg, n):
    out = torch.zeros((n,) + src.shape[1:], dtype=src.dtype)
    return out.index_add_(0, seg, src)
def _pad(x, pw):
    flat = tuple(v for pair in reversed(pw) for v in pair)
    return torch.nn.functional.pad(x, flat)

kernel_name = 'standalone__mha_softmax__near_ridge'

def setup_inputs():

    _w = (lambda a: (lambda t: t.to(torch.bfloat16) if t.is_floating_point() else t)(torch.as_tensor(a)))
    B, H, Sq, Sk, D = 8, 16, 384, 1024, 256
    return {
        "q": _w((lambda *s: torch.randn(*s, dtype=torch.bfloat16) * 0.8)(B, H, Sq, D)),
        "k": _w((lambda *s: torch.randn(*s, dtype=torch.bfloat16) * 0.8)(B, H, Sk, D)),
        "v": _w((lambda *s: torch.randn(*s, dtype=torch.bfloat16) * 0.05)(B, H, Sk, D)),
    }

def reference(q, k, v):
    scale = q.shape[-1] ** -0.5
    scores = torch.einsum("bhqd,bhkd->bhqk", q, k) * scale
    p = _softmax(scores, axis=-1)
    return torch.einsum("bhqk,bhkd->bhqd", p, v)
```

```asm
; @launch grid=(256,1,1) block=(256,1,1) lds=131072
.amdgcn_target "amdgcn-amd-amdhsa--gfx950"
.text
.globl standalone__mha_softmax__near_ridge_kernel
.p2align 8
.type standalone__mha_softmax__near_ridge_kernel,@function
standalone__mha_softmax__near_ridge_kernel:
    s_cmp_ge_u32 s2, 256
    s_cbranch_scc1 L_end
    s_load_dwordx4 s[36:39], s[0:1], 0
    s_load_dwordx4 s[40:43], s[0:1], 16
    v_lshrrev_b32 v1, 6, v0
    s_nop 0
    v_readfirstlane_b32 s44, v1
    v_and_b32 v0, 63, v0
    s_lshr_b32 s45, s2, 4
    s_lshl_b32 s45, s45, 3
    s_and_b32 s46, s2, 7
    s_add_u32 s45, s45, s46
    s_lshr_b32 s46, s2, 3
    s_and_b32 s46, s46, 1
    s_waitcnt lgkmcnt(0)
    s_mov_b32 s8, s36
    s_and_b32 s9, s37, 0xffff
    s_mov_b32 s10, 25165824
    s_mov_b32 s11, 0x00020000
    s_mov_b32 s12, s38
    s_and_b32 s13, s39, 0xffff
    s_mov_b32 s14, 67108864
    s_mov_b32 s15, 0x00020000
    s_mov_b32 s16, s40
    s_and_b32 s17, s41, 0xffff
    s_mov_b32 s18, 67108864
    s_mov_b32 s19, 0x00020000
    s_mov_b32 s20, s42
    s_and_b32 s21, s43, 0xffff
    s_mov_b32 s22, 25165824
    s_mov_b32 s23, 0x00020000
    s_mov_b32 s24, 0x3db8aa3b
    s_mov_b32 s25, 0x44800000
    s_lshl_b32 s27, s44, 13
    s_mul_i32 s47, s45, 384
    s_mul_i32 s48, s46, 192
    s_add_u32 s47, s47, s48
    s_mul_i32 s48, s44, 48
    s_add_u32 s47, s47, s48
    s_lshl_b32 s32, s47, 9
    s_lshl_b32 s49, s45, 19
    s_add_u32 s28, s49, s27
    s_add_u32 s29, s28, 4096
    s_mov_b32 s30, s28
    s_mov_b32 s31, s29
    v_and_b32 v5, 15, v0
    v_lshrrev_b32 v6, 4, v0
    v_lshlrev_b32 v7, 9, v5
    v_lshl_add_u32 v7, v6, 4, v7
    v_lshrrev_b32 v1, 5, v0
    v_and_b32 v254, 31, v0
    v_lshlrev_b32 v255, 1, v1
    v_lshlrev_b32 v1, 9, v1
    v_add_u32 v248, 0, v255
    v_xor_b32 v248, v254, v248
    v_lshl_add_u32 v232, v248, 4, v1
    v_add_u32 v248, 4, v255
    v_xor_b32 v248, v254, v248
    v_lshl_add_u32 v233, v248, 4, v1
    v_add_u32 v248, 8, v255
    v_xor_b32 v248, v254, v248
    v_lshl_add_u32 v234, v248, 4, v1
    v_add_u32 v248, 12, v255
    v_xor_b32 v248, v254, v248
    v_lshl_add_u32 v235, v248, 4, v1
    s_add_u32 m0, s27, 0
    s_nop 0
    buffer_load_dwordx4 v232, s[12:15], s28 offen offset:0 lds
    buffer_load_dwordx4 v233, s[12:15], s28 offen offset:1024 lds
    buffer_load_dwordx4 v234, s[12:15], s28 offen offset:2048 lds
    buffer_load_dwordx4 v235, s[12:15], s28 offen offset:3072 lds
    s_add_u32 m0, s27, 4096
    s_nop 0
    buffer_load_dwordx4 v232, s[12:15], s29 offen offset:0 lds
    buffer_load_dwordx4 v233, s[12:15], s29 offen offset:1024 lds
    buffer_load_dwordx4 v234, s[12:15], s29 offen offset:2048 lds
    buffer_load_dwordx4 v235, s[12:15], s29 offen offset:3072 lds
    s_add_u32 s28, s28, 32768
    s_add_u32 s29, s29, 32768
    s_add_u32 s33, s32, 0
    buffer_load_dwordx4 a[192:195], v7, s[8:11], s33 offen offset:0
    buffer_load_dwordx4 a[196:199], v7, s[8:11], s33 offen offset:64
    buffer_load_dwordx4 a[200:203], v7, s[8:11], s33 offen offset:128
    buffer_load_dwordx4 a[204:207], v7, s[8:11], s33 offen offset:192
    buffer_load_dwordx4 a[208:211], v7, s[8:11], s33 offen offset:256
    buffer_load_dwordx4 a[212:215], v7, s[8:11], s33 offen offset:320
    buffer_load_dwordx4 a[216:219], v7, s[8:11], s33 offen offset:384
    buffer_load_dwordx4 a[220:223], v7, s[8:11], s33 offen offset:448
    s_add_u32 s33, s32, 8192
    buffer_load_dwordx4 a[224:227], v7, s[8:11], s33 offen offset:0
    buffer_load_dwordx4 a[228:231], v7, s[8:11], s33 offen offset:64
    buffer_load_dwordx4 a[232:235], v7, s[8:11], s33 offen offset:128
    buffer_load_dwordx4 a[236:239], v7, s[8:11], s33 offen offset:192
    buffer_load_dwordx4 a[240:243], v7, s[8:11], s33 offen offset:256
    buffer_load_dwordx4 a[244:247], v7, s[8:11], s33 offen offset:320
    buffer_load_dwordx4 a[248:251], v7, s[8:11], s33 offen offset:384
    buffer_load_dwordx4 a[252:255], v7, s[8:11], s33 offen offset:448
    s_add_u32 s33, s32, 16384
    buffer_load_dwordx4 v[184:187], v7, s[8:11], s33 offen offset:0
    buffer_load_dwordx4 v[188:191], v7, s[8:11], s33 offen offset:64
    buffer_load_dwordx4 v[192:195], v7, s[8:11], s33 offen offset:128
    buffer_load_dwordx4 v[196:199], v7, s[8:11], s33 offen offset:192
    buffer_load_dwordx4 v[200:203], v7, s[8:11], s33 offen offset:256
    buffer_load_dwordx4 v[204:207], v7, s[8:11], s33 offen offset:320
    buffer_load_dwordx4 v[208:211], v7, s[8:11], s33 offen offset:384
    buffer_load_dwordx4 v[212:215], v7, s[8:11], s33 offen offset:448
    s_add_u32 m0, s27, 65536
    s_nop 0
    buffer_load_dwordx4 v232, s[16:19], s30 offen offset:0 lds
    buffer_load_dwordx4 v233, s[16:19], s30 offen offset:1024 lds
    buffer_load_dwordx4 v234, s[16:19], s30 offen offset:2048 lds
    buffer_load_dwordx4 v235, s[16:19], s30 offen offset:3072 lds
    s_add_u32 m0, s27, 69632
    s_nop 0
    buffer_load_dwordx4 v232, s[16:19], s31 offen offset:0 lds
    buffer_load_dwordx4 v233, s[16:19], s31 offen offset:1024 lds
    buffer_load_dwordx4 v234, s[16:19], s31 offen offset:2048 lds
    buffer_load_dwordx4 v235, s[16:19], s31 offen offset:3072 lds
    s_add_u32 s30, s30, 32768
    s_add_u32 s31, s31, 32768
    s_add_u32 m0, s27, 32768
    s_nop 0
    buffer_load_dwordx4 v232, s[12:15], s28 offen offset:0 lds
    buffer_load_dwordx4 v233, s[12:15], s28 offen offset:1024 lds
    buffer_load_dwordx4 v234, s[12:15], s28 offen offset:2048 lds
    buffer_load_dwordx4 v235, s[12:15], s28 offen offset:3072 lds
    s_add_u32 m0, s27, 36864
    s_nop 0
    buffer_load_dwordx4 v232, s[12:15], s29 offen offset:0 lds
    buffer_load_dwordx4 v233, s[12:15], s29 offen offset:1024 lds
    buffer_load_dwordx4 v234, s[12:15], s29 offen offset:2048 lds
    buffer_load_dwordx4 v235, s[12:15], s29 offen offset:3072 lds
    s_add_u32 s28, s28, 32768
    s_add_u32 s29, s29, 32768
    v_and_b32 v254, 7, v5
    v_lshlrev_b32 v254, 1, v254
    v_lshlrev_b32 v255, 9, v5
    v_add_u32 v248, 0, v6
    v_xor_b32 v248, v248, v254
    v_lshl_add_u32 v216, v248, 4, v255
    v_add_u32 v248, 4, v6
    v_xor_b32 v248, v248, v254
    v_lshl_add_u32 v217, v248, 4, v255
    v_add_u32 v248, 8, v6
    v_xor_b32 v248, v248, v254
    v_lshl_add_u32 v218, v248, 4, v255
    v_add_u32 v248, 12, v6
    v_xor_b32 v248, v248, v254
    v_lshl_add_u32 v219, v248, 4, v255
    v_add_u32 v248, 16, v6
    v_xor_b32 v248, v248, v254
    v_lshl_add_u32 v220, v248, 4, v255
    v_add_u32 v248, 20, v6
    v_xor_b32 v248, v248, v254
    v_lshl_add_u32 v221, v248, 4, v255
    v_add_u32 v248, 24, v6
    v_xor_b32 v248, v248, v254
    v_lshl_add_u32 v222, v248, 4, v255
    v_add_u32 v248, 28, v6
    v_xor_b32 v248, v248, v254
    v_lshl_add_u32 v223, v248, 4, v255
    v_lshrrev_b32 v254, 2, v5
    v_lshl_add_u32 v254, v6, 2, v254
    v_and_b32 v255, 7, v254
    v_lshlrev_b32 v255, 1, v255
    v_lshlrev_b32 v254, 9, v254
    v_and_b32 v249, 1, v5
    v_lshl_add_u32 v254, v249, 3, v254
    v_add_u32 v254, 65536, v254
    v_bfe_u32 v249, v5, 1, 1
    v_add_u32 v248, 0, v249
    v_xor_b32 v248, v248, v255
    v_lshl_add_u32 v224, v248, 4, v254
    v_add_u32 v248, 2, v249
    v_xor_b32 v248, v248, v255
    v_lshl_add_u32 v225, v248, 4, v254
    v_add_u32 v248, 4, v249
    v_xor_b32 v248, v248, v255
    v_lshl_add_u32 v226, v248, 4, v254
    v_add_u32 v248, 6, v249
    v_xor_b32 v248, v248, v255
    v_lshl_add_u32 v227, v248, 4, v254
    v_add_u32 v248, 8, v249
    v_xor_b32 v248, v248, v255
    v_lshl_add_u32 v228, v248, 4, v254
    v_add_u32 v248, 10, v249
    v_xor_b32 v248, v248, v255
    v_lshl_add_u32 v229, v248, 4, v254
    v_add_u32 v248, 12, v249
    v_xor_b32 v248, v248, v255
    v_lshl_add_u32 v230, v248, 4, v254
    v_add_u32 v248, 14, v249
    v_xor_b32 v248, v248, v255
    v_lshl_add_u32 v231, v248, 4, v254
    v_accvgpr_write_b32 a0, 0
    v_accvgpr_write_b32 a1, 0
    v_accvgpr_write_b32 a2, 0
    v_accvgpr_write_b32 a3, 0
    v_accvgpr_write_b32 a4, 0
    v_accvgpr_write_b32 a5, 0
    v_accvgpr_write_b32 a6, 0
    v_accvgpr_write_b32 a7, 0
    v_accvgpr_write_b32 a8, 0
    v_accvgpr_write_b32 a9, 0
    v_accvgpr_write_b32 a10, 0
    v_accvgpr_write_b32 a11, 0
    v_accvgpr_write_b32 a12, 0
    v_accvgpr_write_b32 a13, 0
    v_accvgpr_write_b32 a14, 0
    v_accvgpr_write_b32 a15, 0
    v_accvgpr_write_b32 a16, 0
    v_accvgpr_write_b32 a17, 0
    v_accvgpr_write_b32 a18, 0
    v_accvgpr_write_b32 a19, 0
    v_accvgpr_write_b32 a20, 0
    v_accvgpr_write_b32 a21, 0
    v_accvgpr_write_b32 a22, 0
    v_accvgpr_write_b32 a23, 0
    v_accvgpr_write_b32 a24, 0
    v_accvgpr_write_b32 a25, 0
    v_accvgpr_write_b32 a26, 0
    v_accvgpr_write_b32 a27, 0
    v_accvgpr_write_b32 a28, 0
    v_accvgpr_write_b32 a29, 0
    v_accvgpr_write_b32 a30, 0
    v_accvgpr_write_b32 a31, 0
    v_accvgpr_write_b32 a32, 0
    v_accvgpr_write_b32 a33, 0
    v_accvgpr_write_b32 a34, 0
    v_accvgpr_write_b32 a35, 0
    v_accvgpr_write_b32 a36, 0
    v_accvgpr_write_b32 a37, 0
    v_accvgpr_write_b32 a38, 0
    v_accvgpr_write_b32 a39, 0
    v_accvgpr_write_b32 a40, 0
    v_accvgpr_write_b32 a41, 0
    v_accvgpr_write_b32 a42, 0
    v_accvgpr_write_b32 a43, 0
    v_accvgpr_write_b32 a44, 0
    v_accvgpr_write_b32 a45, 0
    v_accvgpr_write_b32 a46, 0
    v_accvgpr_write_b32 a47, 0
    v_accvgpr_write_b32 a48, 0
    v_accvgpr_write_b32 a49, 0
    v_accvgpr_write_b32 a50, 0
    v_accvgpr_write_b32 a51, 0
    v_accvgpr_write_b32 a52, 0
    v_accvgpr_write_b32 a53, 0
    v_accvgpr_write_b32 a54, 0
    v_accvgpr_write_b32 a55, 0
    v_accvgpr_write_b32 a56, 0
    v_accvgpr_write_b32 a57, 0
    v_accvgpr_write_b32 a58, 0
    v_accvgpr_write_b32 a59, 0
    v_accvgpr_write_b32 a60, 0
    v_accvgpr_write_b32 a61, 0
    v_accvgpr_write_b32 a62, 0
    v_accvgpr_write_b32 a63, 0
    v_accvgpr_write_b32 a64, 0
    v_accvgpr_write_b32 a65, 0
    v_accvgpr_write_b32 a66, 0
    v_accvgpr_write_b32 a67, 0
    v_accvgpr_write_b32 a68, 0
    v_accvgpr_write_b32 a69, 0
    v_accvgpr_write_b32 a70, 0
    v_accvgpr_write_b32 a71, 0
    v_accvgpr_write_b32 a72, 0
    v_accvgpr_write_b32 a73, 0
    v_accvgpr_write_b32 a74, 0
    v_accvgpr_write_b32 a75, 0
    v_accvgpr_write_b32 a76, 0
    v_accvgpr_write_b32 a77, 0
    v_accvgpr_write_b32 a78, 0
    v_accvgpr_write_b32 a79, 0
    v_accvgpr_write_b32 a80, 0
    v_accvgpr_write_b32 a81, 0
    v_accvgpr_write_b32 a82, 0
    v_accvgpr_write_b32 a83, 0
    v_accvgpr_write_b32 a84, 0
    v_accvgpr_write_b32 a85, 0
    v_accvgpr_write_b32 a86, 0
    v_accvgpr_write_b32 a87, 0
    v_accvgpr_write_b32 a88, 0
    v_accvgpr_write_b32 a89, 0
    v_accvgpr_write_b32 a90, 0
    v_accvgpr_write_b32 a91, 0
    v_accvgpr_write_b32 a92, 0
    v_accvgpr_write_b32 a93, 0
    v_accvgpr_write_b32 a94, 0
    v_accvgpr_write_b32 a95, 0
    v_accvgpr_write_b32 a96, 0
    v_accvgpr_write_b32 a97, 0
    v_accvgpr_write_b32 a98, 0
    v_accvgpr_write_b32 a99, 0
    v_accvgpr_write_b32 a100, 0
    v_accvgpr_write_b32 a101, 0
    v_accvgpr_write_b32 a102, 0
    v_accvgpr_write_b32 a103, 0
    v_accvgpr_write_b32 a104, 0
    v_accvgpr_write_b32 a105, 0
    v_accvgpr_write_b32 a106, 0
    v_accvgpr_write_b32 a107, 0
    v_accvgpr_write_b32 a108, 0
    v_accvgpr_write_b32 a109, 0
    v_accvgpr_write_b32 a110, 0
    v_accvgpr_write_b32 a111, 0
    v_accvgpr_write_b32 a112, 0
    v_accvgpr_write_b32 a113, 0
    v_accvgpr_write_b32 a114, 0
    v_accvgpr_write_b32 a115, 0
    v_accvgpr_write_b32 a116, 0
    v_accvgpr_write_b32 a117, 0
    v_accvgpr_write_b32 a118, 0
    v_accvgpr_write_b32 a119, 0
    v_accvgpr_write_b32 a120, 0
    v_accvgpr_write_b32 a121, 0
    v_accvgpr_write_b32 a122, 0
    v_accvgpr_write_b32 a123, 0
    v_accvgpr_write_b32 a124, 0
    v_accvgpr_write_b32 a125, 0
    v_accvgpr_write_b32 a126, 0
    v_accvgpr_write_b32 a127, 0
    v_accvgpr_write_b32 a128, 0
    v_accvgpr_write_b32 a129, 0
    v_accvgpr_write_b32 a130, 0
    v_accvgpr_write_b32 a131, 0
    v_accvgpr_write_b32 a132, 0
    v_accvgpr_write_b32 a133, 0
    v_accvgpr_write_b32 a134, 0
    v_accvgpr_write_b32 a135, 0
    v_accvgpr_write_b32 a136, 0
    v_accvgpr_write_b32 a137, 0
    v_accvgpr_write_b32 a138, 0
    v_accvgpr_write_b32 a139, 0
    v_accvgpr_write_b32 a140, 0
    v_accvgpr_write_b32 a141, 0
    v_accvgpr_write_b32 a142, 0
    v_accvgpr_write_b32 a143, 0
    v_accvgpr_write_b32 a144, 0
    v_accvgpr_write_b32 a145, 0
    v_accvgpr_write_b32 a146, 0
    v_accvgpr_write_b32 a147, 0
    v_accvgpr_write_b32 a148, 0
    v_accvgpr_write_b32 a149, 0
    v_accvgpr_write_b32 a150, 0
    v_accvgpr_write_b32 a151, 0
    v_accvgpr_write_b32 a152, 0
    v_accvgpr_write_b32 a153, 0
    v_accvgpr_write_b32 a154, 0
    v_accvgpr_write_b32 a155, 0
    v_accvgpr_write_b32 a156, 0
    v_accvgpr_write_b32 a157, 0
    v_accvgpr_write_b32 a158, 0
    v_accvgpr_write_b32 a159, 0
    v_accvgpr_write_b32 a160, 0
    v_accvgpr_write_b32 a161, 0
    v_accvgpr_write_b32 a162, 0
    v_accvgpr_write_b32 a163, 0
    v_accvgpr_write_b32 a164, 0
    v_accvgpr_write_b32 a165, 0
    v_accvgpr_write_b32 a166, 0
    v_accvgpr_write_b32 a167, 0
    v_accvgpr_write_b32 a168, 0
    v_accvgpr_write_b32 a169, 0
    v_accvgpr_write_b32 a170, 0
    v_accvgpr_write_b32 a171, 0
    v_accvgpr_write_b32 a172, 0
    v_accvgpr_write_b32 a173, 0
    v_accvgpr_write_b32 a174, 0
    v_accvgpr_write_b32 a175, 0
    v_accvgpr_write_b32 a176, 0
    v_accvgpr_write_b32 a177, 0
    v_accvgpr_write_b32 a178, 0
    v_accvgpr_write_b32 a179, 0
    v_accvgpr_write_b32 a180, 0
    v_accvgpr_write_b32 a181, 0
    v_accvgpr_write_b32 a182, 0
    v_accvgpr_write_b32 a183, 0
    v_accvgpr_write_b32 a184, 0
    v_accvgpr_write_b32 a185, 0
    v_accvgpr_write_b32 a186, 0
    v_accvgpr_write_b32 a187, 0
    v_accvgpr_write_b32 a188, 0
    v_accvgpr_write_b32 a189, 0
    v_accvgpr_write_b32 a190, 0
    v_accvgpr_write_b32 a191, 0
    v_mov_b32 v2, 0xff800000
    v_mov_b32 v239, 0
    v_mov_b32 v3, 0xff800000
    v_mov_b32 v240, 0
    v_mov_b32 v4, 0xff800000
    v_mov_b32 v241, 0
    s_waitcnt vmcnt(16)
    s_barrier
    ds_read_b128 v[152:155], v216 offset:0
    ds_read_b128 v[156:159], v217 offset:0
    ds_read_b128 v[160:163], v218 offset:0
    ds_read_b128 v[164:167], v219 offset:0
    ds_read_b128 v[168:171], v220 offset:0
    s_waitcnt lgkmcnt(4)
    v_mfma_f32_16x16x32_bf16 v[8:11], v[152:155], a[192:195], 0
    v_mfma_f32_16x16x32_bf16 v[12:15], v[152:155], a[224:227], 0
    v_mfma_f32_16x16x32_bf16 v[16:19], v[152:155], v[184:187], 0
    ds_read_b128 v[172:175], v221 offset:0
    s_waitcnt lgkmcnt(4)
    v_mfma_f32_16x16x32_bf16 v[8:11], v[156:159], a[196:199], v[8:11]
    v_mfma_f32_16x16x32_bf16 v[12:15], v[156:159], a[228:231], v[12:15]
    v_mfma_f32_16x16x32_bf16 v[16:19], v[156:159], v[188:191], v[16:19]
    ds_read_b128 v[176:179], v222 offset:0
    s_waitcnt lgkmcnt(4)
    v_mfma_f32_16x16x32_bf16 v[8:11], v[160:163], a[200:203], v[8:11]
    v_mfma_f32_16x16x32_bf16 v[12:15], v[160:163], a[232:235], v[12:15]
    v_mfma_f32_16x16x32_bf16 v[16:19], v[160:163], v[192:195], v[16:19]
    ds_read_b128 v[180:183], v223 offset:0
    s_waitcnt lgkmcnt(4)
    v_mfma_f32_16x16x32_bf16 v[8:11], v[164:167], a[204:207], v[8:11]
    v_mfma_f32_16x16x32_bf16 v[12:15], v[164:167], a[236:239], v[12:15]
    v_mfma_f32_16x16x32_bf16 v[16:19], v[164:167], v[196:199], v[16:19]
    ds_read_b128 v[152:155], v216 offset:8192
    s_waitcnt lgkmcnt(4)
    v_mfma_f32_16x16x32_bf16 v[8:11], v[168:171], a[208:211], v[8:11]
    v_mfma_f32_16x16x32_bf16 v[12:15], v[168:171], a[240:243], v[12:15]
    v_mfma_f32_16x16x32_bf16 v[16:19], v[168:171], v[200:203], v[16:19]
    ds_read_b128 v[156:159], v217 offset:8192
    s_waitcnt lgkmcnt(4)
    v_mfma_f32_16x16x32_bf16 v[8:11], v[172:175], a[212:215], v[8:11]
    v_mfma_f32_16x16x32_bf16 v[12:15], v[172:175], a[244:247], v[12:15]
    v_mfma_f32_16x16x32_bf16 v[16:19], v[172:175], v[204:207], v[16:19]
    ds_read_b128 v[160:163], v218 offset:8192
    s_waitcnt lgkmcnt(4)
    v_mfma_f32_16x16x32_bf16 v[8:11], v[176:179], a[216:219], v[8:11]
    v_mfma_f32_16x16x32_bf16 v[12:15], v[176:179], a[248:251], v[12:15]
    v_mfma_f32_16x16x32_bf16 v[16:19], v[176:179], v[208:211], v[16:19]
    ds_read_b128 v[164:167], v219 offset:8192
    s_waitcnt lgkmcnt(4)
    v_mfma_f32_16x16x32_bf16 v[8:11], v[180:183], a[220:223], v[8:11]
    v_mfma_f32_16x16x32_bf16 v[12:15], v[180:183], a[252:255], v[12:15]
    v_mfma_f32_16x16x32_bf16 v[16:19], v[180:183], v[212:215], v[16:19]
    ds_read_b128 v[168:171], v220 offset:8192
    s_waitcnt lgkmcnt(4)
    v_mfma_f32_16x16x32_bf16 v[20:23], v[152:155], a[192:195], 0
    v_mfma_f32_16x16x32_bf16 v[24:27], v[152:155], a[224:227], 0
    v_mfma_f32_16x16x32_bf16 v[28:31], v[152:155], v[184:187], 0
    ds_read_b128 v[172:175], v221 offset:8192
    s_waitcnt lgkmcnt(4)
    v_mfma_f32_16x16x32_bf16 v[20:23], v[156:159], a[196:199], v[20:23]
    v_mfma_f32_16x16x32_bf16 v[24:27], v[156:159], a[228:231], v[24:27]
    v_mfma_f32_16x16x32_bf16 v[28:31], v[156:159], v[188:191], v[28:31]
    ds_read_b128 v[176:179], v222 offset:8192
    s_waitcnt lgkmcnt(4)
    v_mfma_f32_16x16x32_bf16 v[20:23], v[160:163], a[200:203], v[20:23]
    v_mfma_f32_16x16x32_bf16 v[24:27], v[160:163], a[232:235], v[24:27]
    v_mfma_f32_16x16x32_bf16 v[28:31], v[160:163], v[192:195], v[28:31]
    ds_read_b128 v[180:183], v223 offset:8192
    s_waitcnt lgkmcnt(4)
    v_mfma_f32_16x16x32_bf16 v[20:23], v[164:167], a[204:207], v[20:23]
    v_mfma_f32_16x16x32_bf16 v[24:27], v[164:167], a[236:239], v[24:27]
    v_mfma_f32_16x16x32_bf16 v[28:31], v[164:167], v[196:199], v[28:31]
    ds_read_b128 v[152:155], v216 offset:16384
    s_waitcnt lgkmcnt(4)
    v_mfma_f32_16x16x32_bf16 v[20:23], v[168:171], a[208:211], v[20:23]
    v_mfma_f32_16x16x32_bf16 v[24:27], v[168:171], a[240:243], v[24:27]
    v_mfma_f32_16x16x32_bf16 v[28:31], v[168:171], v[200:203], v[28:31]
    ds_read_b128 v[156:159], v217 offset:16384
    s_waitcnt lgkmcnt(4)
    v_mfma_f32_16x16x32_bf16 v[20:23], v[172:175], a[212:215], v[20:23]
    v_mfma_f32_16x16x32_bf16 v[24:27], v[172:175], a[244:247], v[24:27]
    v_mfma_f32_16x16x32_bf16 v[28:31], v[172:175], v[204:207], v[28:31]
    ds_read_b128 v[160:163], v218 offset:16384
    s_waitcnt lgkmcnt(4)
    v_mfma_f32_16x16x32_bf16 v[20:23], v[176:179], a[216:219], v[20:23]
    v_mfma_f32_16x16x32_bf16 v[24:27], v[176:179], a[248:251], v[24:27]
    v_mfma_f32_16x16x32_bf16 v[28:31], v[176:179], v[208:211], v[28:31]
    ds_read_b128 v[164:167], v219 offset:16384
    s_waitcnt lgkmcnt(4)
    v_mfma_f32_16x16x32_bf16 v[20:23], v[180:183], a[220:223], v[20:23]
    v_mfma_f32_16x16x32_bf16 v[24:27], v[180:183], a[252:255], v[24:27]
    v_mfma_f32_16x16x32_bf16 v[28:31], v[180:183], v[212:215], v[28:31]
    ds_read_b128 v[168:171], v220 offset:16384
    s_waitcnt lgkmcnt(4)
    v_mfma_f32_16x16x32_bf16 v[32:35], v[152:155], a[192:195], 0
    v_mfma_f32_16x16x32_bf16 v[36:39], v[152:155], a[224:227], 0
    v_mfma_f32_16x16x32_bf16 v[40:43], v[152:155], v[184:187], 0
    ds_read_b128 v[172:175], v221 offset:16384
    s_waitcnt lgkmcnt(4)
    v_mfma_f32_16x16x32_bf16 v[32:35], v[156:159], a[196:199], v[32:35]
    v_mfma_f32_16x16x32_bf16 v[36:39], v[156:159], a[228:231], v[36:39]
    v_mfma_f32_16x16x32_bf16 v[40:43], v[156:159], v[188:191], v[40:43]
    ds_read_b128 v[176:179], v222 offset:16384
    s_waitcnt lgkmcnt(4)
    v_mfma_f32_16x16x32_bf16 v[32:35], v[160:163], a[200:203], v[32:35]
    v_mfma_f32_16x16x32_bf16 v[36:39], v[160:163], a[232:235], v[36:39]
    v_mfma_f32_16x16x32_bf16 v[40:43], v[160:163], v[192:195], v[40:43]
    ds_read_b128 v[180:183], v223 offset:16384
    s_waitcnt lgkmcnt(4)
    v_mfma_f32_16x16x32_bf16 v[32:35], v[164:167], a[204:207], v[32:35]
    v_mfma_f32_16x16x32_bf16 v[36:39], v[164:167], a[236:239], v[36:39]
    v_mfma_f32_16x16x32_bf16 v[40:43], v[164:167], v[196:199], v[40:43]
    ds_read_b128 v[152:155], v216 offset:24576
    s_waitcnt lgkmcnt(4)
    v_mfma_f32_16x16x32_bf16 v[32:35], v[168:171], a[208:211], v[32:35]
    v_mfma_f32_16x16x32_bf16 v[36:39], v[168:171], a[240:243], v[36:39]
    v_mfma_f32_16x16x32_bf16 v[40:43], v[168:171], v[200:203], v[40:43]
    ds_read_b128 v[156:159], v217 offset:24576
    s_waitcnt lgkmcnt(4)
    v_mfma_f32_16x16x32_bf16 v[32:35], v[172:175], a[212:215], v[32:35]
    v_mfma_f32_16x16x32_bf16 v[36:39], v[172:175], a[244:247], v[36:39]
    v_mfma_f32_16x16x32_bf16 v[40:43], v[172:175], v[204:207], v[40:43]
    ds_read_b128 v[160:163], v218 offset:24576
    s_waitcnt lgkmcnt(4)
    v_mfma_f32_16x16x32_bf16 v[32:35], v[176:179], a[216:219], v[32:35]
    v_mfma_f32_16x16x32_bf16 v[36:39], v[176:179], a[248:251], v[36:39]
    v_mfma_f32_16x16x32_bf16 v[40:43], v[176:179], v[208:211], v[40:43]
    ds_read_b128 v[164:167], v219 offset:24576
    s_waitcnt lgkmcnt(4)
    v_mfma_f32_16x16x32_bf16 v[32:35], v[180:183], a[220:223], v[32:35]
    v_mfma_f32_16x16x32_bf16 v[36:39], v[180:183], a[252:255], v[36:39]
    v_mfma_f32_16x16x32_bf16 v[40:43], v[180:183], v[212:215], v[40:43]
    ds_read_b128 v[168:171], v220 offset:24576
    s_waitcnt lgkmcnt(4)
    v_mfma_f32_16x16x32_bf16 v[44:47], v[152:155], a[192:195], 0
    v_mfma_f32_16x16x32_bf16 v[48:51], v[152:155], a[224:227], 0
    v_mfma_f32_16x16x32_bf16 v[52:55], v[152:155], v[184:187], 0
    ds_read_b128 v[172:175], v221 offset:24576
    s_waitcnt lgkmcnt(4)
    v_mfma_f32_16x16x32_bf16 v[44:47], v[156:159], a[196:199], v[44:47]
    v_mfma_f32_16x16x32_bf16 v[48:51], v[156:159], a[228:231], v[48:51]
    v_mfma_f32_16x16x32_bf16 v[52:55], v[156:159], v[188:191], v[52:55]
    ds_read_b128 v[176:179], v222 offset:24576
    s_waitcnt lgkmcnt(4)
    v_mfma_f32_16x16x32_bf16 v[44:47], v[160:163], a[200:203], v[44:47]
    v_mfma_f32_16x16x32_bf16 v[48:51], v[160:163], a[232:235], v[48:51]
    v_mfma_f32_16x16x32_bf16 v[52:55], v[160:163], v[192:195], v[52:55]
    ds_read_b128 v[180:183], v223 offset:24576
    s_waitcnt lgkmcnt(4)
    v_mfma_f32_16x16x32_bf16 v[44:47], v[164:167], a[204:207], v[44:47]
    v_mfma_f32_16x16x32_bf16 v[48:51], v[164:167], a[236:239], v[48:51]
    v_mfma_f32_16x16x32_bf16 v[52:55], v[164:167], v[196:199], v[52:55]
    s_waitcnt lgkmcnt(3)
    v_mfma_f32_16x16x32_bf16 v[44:47], v[168:171], a[208:211], v[44:47]
    v_mfma_f32_16x16x32_bf16 v[48:51], v[168:171], a[240:243], v[48:51]
    v_mfma_f32_16x16x32_bf16 v[52:55], v[168:171], v[200:203], v[52:55]
    s_waitcnt lgkmcnt(2)
    v_mfma_f32_16x16x32_bf16 v[44:47], v[172:175], a[212:215], v[44:47]
    v_mfma_f32_16x16x32_bf16 v[48:51], v[172:175], a[244:247], v[48:51]
    v_mfma_f32_16x16x32_bf16 v[52:55], v[172:175], v[204:207], v[52:55]
    s_waitcnt lgkmcnt(1)
    v_mfma_f32_16x16x32_bf16 v[44:47], v[176:179], a[216:219], v[44:47]
    v_mfma_f32_16x16x32_bf16 v[48:51], v[176:179], a[248:251], v[48:51]
    v_mfma_f32_16x16x32_bf16 v[52:55], v[176:179], v[208:211], v[52:55]
    s_waitcnt lgkmcnt(0)
    v_mfma_f32_16x16x32_bf16 v[44:47], v[180:183], a[220:223], v[44:47]
    v_mfma_f32_16x16x32_bf16 v[48:51], v[180:183], a[252:255], v[48:51]
    v_mfma_f32_16x16x32_bf16 v[52:55], v[180:183], v[212:215], v[52:55]
    s_nop 7
    s_nop 1
    v_max3_f32 v254, v8, v9, v10
    v_max3_f32 v254, v254, v11, v20
    v_max3_f32 v254, v254, v21, v22
    v_max3_f32 v254, v254, v23, v32
    v_max3_f32 v254, v254, v33, v34
    v_max3_f32 v254, v254, v35, v44
    v_max3_f32 v254, v254, v45, v46
    v_max_f32 v254, v254, v47
    v_mov_b32 v255, v254
    s_nop 1
    v_permlane32_swap_b32 v254, v255
    v_max_f32 v254, v254, v255
    v_mov_b32 v255, v254
    s_nop 1
    v_permlane16_swap_b32 v254, v255
    v_max_f32 v254, v254, v255
    v_max_f32 v254, v254, v2
    v_sub_f32 v255, v2, v254
    v_mul_f32 v255, s24, v255
    v_exp_f32 v248, v255
    v_mov_b32 v2, v254
    v_mul_f32 v236, -v254, s24
    v_mul_f32 v239, v239, v248
    v_max3_f32 v254, v12, v13, v14
    v_max3_f32 v254, v254, v15, v24
    v_max3_f32 v254, v254, v25, v26
    v_max3_f32 v254, v254, v27, v36
    v_max3_f32 v254, v254, v37, v38
    v_max3_f32 v254, v254, v39, v48
    v_max3_f32 v254, v254, v49, v50
    v_max_f32 v254, v254, v51
    v_mov_b32 v255, v254
    s_nop 1
    v_permlane32_swap_b32 v254, v255
    v_max_f32 v254, v254, v255
    v_mov_b32 v255, v254
    s_nop 1
    v_permlane16_swap_b32 v254, v255
    v_max_f32 v254, v254, v255
    v_max_f32 v254, v254, v3
    v_sub_f32 v255, v3, v254
    v_mul_f32 v255, s24, v255
    v_exp_f32 v249, v255
    v_mov_b32 v3, v254
    v_mul_f32 v237, -v254, s24
    v_mul_f32 v240, v240, v249
    v_max3_f32 v254, v16, v17, v18
    v_max3_f32 v254, v254, v19, v28
    v_max3_f32 v254, v254, v29, v30
    v_max3_f32 v254, v254, v31, v40
    v_max3_f32 v254, v254, v41, v42
    v_max3_f32 v254, v254, v43, v52
    v_max3_f32 v254, v254, v53, v54
    v_max_f32 v254, v254, v55
    v_mov_b32 v255, v254
    s_nop 1
    v_permlane32_swap_b32 v254, v255
    v_max_f32 v254, v254, v255
    v_mov_b32 v255, v254
    s_nop 1
    v_permlane16_swap_b32 v254, v255
    v_max_f32 v254, v254, v255
    v_max_f32 v254, v254, v4
    v_sub_f32 v255, v4, v254
    v_mul_f32 v255, s24, v255
    v_exp_f32 v250, v255
    v_mov_b32 v4, v254
    v_mul_f32 v238, -v254, s24
    v_mul_f32 v241, v241, v250
    v_fma_f32 v248, v8, s24, v236
    v_fma_f32 v249, v9, s24, v236
    v_fma_f32 v250, v10, s24, v236
    v_fma_f32 v251, v11, s24, v236
    v_exp_f32 v248, v248
    v_exp_f32 v249, v249
    v_fma_f32 v252, v12, s24, v237
    v_fma_f32 v253, v13, s24, v237
    v_exp_f32 v250, v250
    v_exp_f32 v251, v251
    v_add_f32 v242, v248, v249
    v_cvt_pk_bf16_f32 v104, v248, v249
    v_fma_f32 v248, v14, s24, v237
    v_fma_f32 v249, v15, s24, v237
    v_exp_f32 v252, v252
    v_exp_f32 v253, v253
    v_add_f32 v242, v242, v250
    v_add_f32 v242, v242, v251
    v_cvt_pk_bf16_f32 v105, v250, v251
    v_fma_f32 v250, v16, s24, v238
    v_fma_f32 v251, v17, s24, v238
    v_exp_f32 v248, v248
    v_exp_f32 v249, v249
    v_add_f32 v243, v252, v253
    v_cvt_pk_bf16_f32 v108, v252, v253
    v_fma_f32 v252, v18, s24, v238
    v_fma_f32 v253, v19, s24, v238
    v_exp_f32 v250, v250
    v_exp_f32 v251, v251
    v_add_f32 v243, v243, v248
    v_add_f32 v243, v243, v249
    v_cvt_pk_bf16_f32 v109, v248, v249
    v_fma_f32 v248, v20, s24, v236
    v_fma_f32 v249, v21, s24, v236
    v_exp_f32 v252, v252
    v_exp_f32 v253, v253
    v_add_f32 v244, v250, v251
    v_cvt_pk_bf16_f32 v112, v250, v251
    v_fma_f32 v250, v22, s24, v236
    v_fma_f32 v251, v23, s24, v236
    v_exp_f32 v248, v248
    v_exp_f32 v249, v249
    v_add_f32 v244, v244, v252
    v_add_f32 v244, v244, v253
    v_cvt_pk_bf16_f32 v113, v252, v253
    v_fma_f32 v252, v24, s24, v237
    v_fma_f32 v253, v25, s24, v237
    v_exp_f32 v250, v250
    v_exp_f32 v251, v251
    v_add_f32 v242, v242, v248
    v_add_f32 v242, v242, v249
    v_cvt_pk_bf16_f32 v106, v248, v249
    v_fma_f32 v248, v26, s24, v237
    v_fma_f32 v249, v27, s24, v237
    v_exp_f32 v252, v252
    v_exp_f32 v253, v253
    v_add_f32 v242, v242, v250
    v_add_f32 v242, v242, v251
    v_cvt_pk_bf16_f32 v107, v250, v251
    v_fma_f32 v250, v28, s24, v238
    v_fma_f32 v251, v29, s24, v238
    v_exp_f32 v248, v248
    v_exp_f32 v249, v249
    v_add_f32 v243, v243, v252
    v_add_f32 v243, v243, v253
    v_cvt_pk_bf16_f32 v110, v252, v253
    v_fma_f32 v252, v30, s24, v238
    v_fma_f32 v253, v31, s24, v238
    v_exp_f32 v250, v250
    v_exp_f32 v251, v251
    v_add_f32 v243, v243, v248
    v_add_f32 v243, v243, v249
    v_cvt_pk_bf16_f32 v111, v248, v249
    v_exp_f32 v252, v252
    v_exp_f32 v253, v253
    v_add_f32 v244, v244, v250
    v_add_f32 v244, v244, v251
    v_cvt_pk_bf16_f32 v114, v250, v251
    v_add_f32 v244, v244, v252
    v_add_f32 v244, v244, v253
    v_cvt_pk_bf16_f32 v115, v252, v253
    v_fma_f32 v248, v32, s24, v236
    v_fma_f32 v249, v33, s24, v236
    v_fma_f32 v250, v34, s24, v236
    v_fma_f32 v251, v35, s24, v236
    v_exp_f32 v248, v248
    v_exp_f32 v249, v249
    v_fma_f32 v252, v36, s24, v237
    v_fma_f32 v253, v37, s24, v237
    v_exp_f32 v250, v250
    v_exp_f32 v251, v251
    v_add_f32 v245, v248, v249
    v_cvt_pk_bf16_f32 v116, v248, v249
    v_fma_f32 v248, v38, s24, v237
    v_fma_f32 v249, v39, s24, v237
    v_exp_f32 v252, v252
    v_exp_f32 v253, v253
    v_add_f32 v245, v245, v250
    v_add_f32 v245, v245, v251
    v_cvt_pk_bf16_f32 v117, v250, v251
    v_fma_f32 v250, v40, s24, v238
    v_fma_f32 v251, v41, s24, v238
    v_exp_f32 v248, v248
    v_exp_f32 v249, v249
    v_add_f32 v246, v252, v253
    v_cvt_pk_bf16_f32 v120, v252, v253
    v_fma_f32 v252, v42, s24, v238
    v_fma_f32 v253, v43, s24, v238
    v_exp_f32 v250, v250
    v_exp_f32 v251, v251
    v_add_f32 v246, v246, v248
    v_add_f32 v246, v246, v249
    v_cvt_pk_bf16_f32 v121, v248, v249
    v_fma_f32 v248, v44, s24, v236
    v_fma_f32 v249, v45, s24, v236
    v_exp_f32 v252, v252
    v_exp_f32 v253, v253
    v_add_f32 v247, v250, v251
    v_cvt_pk_bf16_f32 v124, v250, v251
    v_fma_f32 v250, v46, s24, v236
    v_fma_f32 v251, v47, s24, v236
    v_exp_f32 v248, v248
    v_exp_f32 v249, v249
    v_add_f32 v247, v247, v252
    v_add_f32 v247, v247, v253
    v_cvt_pk_bf16_f32 v125, v252, v253
    v_fma_f32 v252, v48, s24, v237
    v_fma_f32 v253, v49, s24, v237
    v_exp_f32 v250, v250
    v_exp_f32 v251, v251
    v_add_f32 v245, v245, v248
    v_add_f32 v245, v245, v249
    v_cvt_pk_bf16_f32 v118, v248, v249
    v_fma_f32 v248, v50, s24, v237
    v_fma_f32 v249, v51, s24, v237
    v_exp_f32 v252, v252
    v_exp_f32 v253, v253
    v_add_f32 v245, v245, v250
    v_add_f32 v245, v245, v251
    v_cvt_pk_bf16_f32 v119, v250, v251
    v_fma_f32 v250, v52, s24, v238
    v_fma_f32 v251, v53, s24, v238
    v_exp_f32 v248, v248
    v_exp_f32 v249, v249
    v_add_f32 v246, v246, v252
    v_add_f32 v246, v246, v253
    v_cvt_pk_bf16_f32 v122, v252, v253
    v_fma_f32 v252, v54, s24, v238
    v_fma_f32 v253, v55, s24, v238
    v_exp_f32 v250, v250
    v_exp_f32 v251, v251
    v_add_f32 v246, v246, v248
    v_add_f32 v246, v246, v249
    v_cvt_pk_bf16_f32 v123, v248, v249
    v_exp_f32 v252, v252
    v_exp_f32 v253, v253
    v_add_f32 v247, v247, v250
    v_add_f32 v247, v247, v251
    v_cvt_pk_bf16_f32 v126, v250, v251
    v_add_f32 v247, v247, v252
    v_add_f32 v247, v247, v253
    v_cvt_pk_bf16_f32 v127, v252, v253
    v_add_f32 v254, v242, v245
    v_add_f32 v255, v243, v246
    v_add_f32 v1, v244, v247
    s_waitcnt vmcnt(0)
    s_barrier
    s_mov_b32 s26, 0
L_loop:
    ds_read_b128 v[152:155], v216 offset:32768
    ds_read_b128 v[156:159], v217 offset:32768
    ds_read_b128 v[160:163], v218 offset:32768
    ds_read_b128 v[164:167], v219 offset:32768
    ds_read_b128 v[168:171], v220 offset:32768
    s_waitcnt lgkmcnt(3)
    v_mfma_f32_16x16x32_bf16 v[56:59], v[152:155], a[192:195], 0
    s_add_u32 m0, s27, 0
    v_mfma_f32_16x16x32_bf16 v[60:63], v[152:155], a[224:227], 0
    s_nop 0
    v_mfma_f32_16x16x32_bf16 v[64:67], v[152:155], v[184:187], 0
    buffer_load_dwordx4 v232, s[12:15], s28 offen offset:0 lds
    ds_read_b128 v[172:175], v221 offset:32768
    v_mfma_f32_16x16x32_bf16 v[56:59], v[156:159], a[196:199], v[56:59]
    v_fma_f32 v248, v32, s24, v236
    v_mfma_f32_16x16x32_bf16 v[60:63], v[156:159], a[228:231], v[60:63]
    v_fma_f32 v249, v33, s24, v236
    v_fma_f32 v250, v34, s24, v236
    v_mfma_f32_16x16x32_bf16 v[64:67], v[156:159], v[188:191], v[64:67]
    v_fma_f32 v251, v35, s24, v236
    ds_read_b128 v[176:179], v222 offset:32768
    s_waitcnt lgkmcnt(3)
    v_mfma_f32_16x16x32_bf16 v[56:59], v[160:163], a[200:203], v[56:59]
    buffer_load_dwordx4 v233, s[12:15], s28 offen offset:1024 lds
    v_mfma_f32_16x16x32_bf16 v[60:63], v[160:163], a[232:235], v[60:63]
    v_exp_f32 v248, v248
    v_mfma_f32_16x16x32_bf16 v[64:67], v[160:163], v[192:195], v[64:67]
    v_exp_f32 v249, v249
    v_fma_f32 v252, v36, s24, v237
    ds_read_b128 v[180:183], v223 offset:32768
    v_mfma_f32_16x16x32_bf16 v[56:59], v[164:167], a[204:207], v[56:59]
    v_fma_f32 v253, v37, s24, v237
    v_mfma_f32_16x16x32_bf16 v[60:63], v[164:167], a[236:239], v[60:63]
    buffer_load_dwordx4 v234, s[12:15], s28 offen offset:2048 lds
    v_mfma_f32_16x16x32_bf16 v[64:67], v[164:167], v[196:199], v[64:67]
    v_exp_f32 v250, v250
    ds_read_b128 v[152:155], v216 offset:40960
    s_waitcnt lgkmcnt(3)
    v_mfma_f32_16x16x32_bf16 v[56:59], v[168:171], a[208:211], v[56:59]
    v_exp_f32 v251, v251
    v_mfma_f32_16x16x32_bf16 v[60:63], v[168:171], a[240:243], v[60:63]
    v_add_f32 v245, v248, v249
    v_cvt_pk_bf16_f32 v116, v248, v249
    v_mfma_f32_16x16x32_bf16 v[64:67], v[168:171], v[200:203], v[64:67]
    buffer_load_dwordx4 v235, s[12:15], s28 offen offset:3072 lds
    ds_read_b128 v[156:159], v217 offset:40960
    v_mfma_f32_16x16x32_bf16 v[56:59], v[172:175], a[212:215], v[56:59]
    v_fma_f32 v248, v38, s24, v237
    v_mfma_f32_16x16x32_bf16 v[60:63], v[172:175], a[244:247], v[60:63]
    v_fma_f32 v249, v39, s24, v237
    v_mfma_f32_16x16x32_bf16 v[64:67], v[172:175], v[204:207], v[64:67]
    v_exp_f32 v252, v252
    v_exp_f32 v253, v253
    ds_read_b128 v[160:163], v218 offset:40960
    s_waitcnt lgkmcnt(3)
    v_mfma_f32_16x16x32_bf16 v[56:59], v[176:179], a[216:219], v[56:59]
    s_add_u32 m0, s27, 4096
    v_mfma_f32_16x16x32_bf16 v[60:63], v[176:179], a[248:251], v[60:63]
    s_nop 0
    v_mfma_f32_16x16x32_bf16 v[64:67], v[176:179], v[208:211], v[64:67]
    buffer_load_dwordx4 v232, s[12:15], s29 offen offset:0 lds
    ds_read_b128 v[164:167], v219 offset:40960
    v_mfma_f32_16x16x32_bf16 v[56:59], v[180:183], a[220:223], v[56:59]
    v_add_f32 v245, v245, v250
    v_add_f32 v245, v245, v251
    v_mfma_f32_16x16x32_bf16 v[60:63], v[180:183], a[252:255], v[60:63]
    v_cvt_pk_bf16_f32 v117, v250, v251
    v_mfma_f32_16x16x32_bf16 v[64:67], v[180:183], v[212:215], v[64:67]
    v_fma_f32 v250, v40, s24, v238
    ds_read_b128 v[168:171], v220 offset:40960
    s_waitcnt lgkmcnt(3)
    v_mfma_f32_16x16x32_bf16 v[68:71], v[152:155], a[192:195], 0
    buffer_load_dwordx4 v233, s[12:15], s29 offen offset:1024 lds
    v_mfma_f32_16x16x32_bf16 v[72:75], v[152:155], a[224:227], 0
    v_fma_f32 v251, v41, s24, v238
    v_mfma_f32_16x16x32_bf16 v[76:79], v[152:155], v[184:187], 0
    v_exp_f32 v248, v248
    v_exp_f32 v249, v249
    ds_read_b128 v[172:175], v221 offset:40960
    v_mfma_f32_16x16x32_bf16 v[68:71], v[156:159], a[196:199], v[68:71]
    v_add_f32 v246, v252, v253
    v_mfma_f32_16x16x32_bf16 v[72:75], v[156:159], a[228:231], v[72:75]
    buffer_load_dwordx4 v234, s[12:15], s29 offen offset:2048 lds
    v_mfma_f32_16x16x32_bf16 v[76:79], v[156:159], v[188:191], v[76:79]
    v_cvt_pk_bf16_f32 v120, v252, v253
    ds_read_b128 v[176:179], v222 offset:40960
    s_waitcnt lgkmcnt(3)
    v_mfma_f32_16x16x32_bf16 v[68:71], v[160:163], a[200:203], v[68:71]
    v_fma_f32 v252, v42, s24, v238
    v_fma_f32 v253, v43, s24, v238
    v_mfma_f32_16x16x32_bf16 v[72:75], v[160:163], a[232:235], v[72:75]
    v_exp_f32 v250, v250
    v_mfma_f32_16x16x32_bf16 v[76:79], v[160:163], v[192:195], v[76:79]
    buffer_load_dwordx4 v235, s[12:15], s29 offen offset:3072 lds
    ds_read_b128 v[180:183], v223 offset:40960
    v_mfma_f32_16x16x32_bf16 v[68:71], v[164:167], a[204:207], v[68:71]
    v_exp_f32 v251, v251
    v_mfma_f32_16x16x32_bf16 v[72:75], v[164:167], a[236:239], v[72:75]
    v_add_f32 v246, v246, v248
    v_add_f32 v246, v246, v249
    v_mfma_f32_16x16x32_bf16 v[76:79], v[164:167], v[196:199], v[76:79]
    v_cvt_pk_bf16_f32 v121, v248, v249
    ds_read_b128 v[152:155], v216 offset:49152
    s_waitcnt lgkmcnt(3)
    v_mfma_f32_16x16x32_bf16 v[68:71], v[168:171], a[208:211], v[68:71]
    s_add_u32 m0, s27, 98304
    v_mfma_f32_16x16x32_bf16 v[72:75], v[168:171], a[240:243], v[72:75]
    s_nop 0
    v_mfma_f32_16x16x32_bf16 v[76:79], v[168:171], v[200:203], v[76:79]
    buffer_load_dwordx4 v232, s[16:19], s30 offen offset:0 lds
    ds_read_b128 v[156:159], v217 offset:49152
    v_mfma_f32_16x16x32_bf16 v[68:71], v[172:175], a[212:215], v[68:71]
    v_fma_f32 v248, v44, s24, v236
    v_fma_f32 v249, v45, s24, v236
    v_mfma_f32_16x16x32_bf16 v[72:75], v[172:175], a[244:247], v[72:75]
    v_exp_f32 v252, v252
    v_mfma_f32_16x16x32_bf16 v[76:79], v[172:175], v[204:207], v[76:79]
    v_exp_f32 v253, v253
    ds_read_b128 v[160:163], v218 offset:49152
    s_waitcnt lgkmcnt(3)
    v_mfma_f32_16x16x32_bf16 v[68:71], v[176:179], a[216:219], v[68:71]
    buffer_load_dwordx4 v233, s[16:19], s30 offen offset:1024 lds
    v_mfma_f32_16x16x32_bf16 v[72:75], v[176:179], a[248:251], v[72:75]
    v_add_f32 v247, v250, v251
    v_cvt_pk_bf16_f32 v124, v250, v251
    v_mfma_f32_16x16x32_bf16 v[76:79], v[176:179], v[208:211], v[76:79]
    v_fma_f32 v250, v46, s24, v236
    ds_read_b128 v[164:167], v219 offset:49152
    v_mfma_f32_16x16x32_bf16 v[68:71], v[180:183], a[220:223], v[68:71]
    v_fma_f32 v251, v47, s24, v236
    v_mfma_f32_16x16x32_bf16 v[72:75], v[180:183], a[252:255], v[72:75]
    buffer_load_dwordx4 v234, s[16:19], s30 offen offset:2048 lds
    v_mfma_f32_16x16x32_bf16 v[76:79], v[180:183], v[212:215], v[76:79]
    v_exp_f32 v248, v248
    v_exp_f32 v249, v249
    ds_read_b128 v[168:171], v220 offset:49152
    s_waitcnt lgkmcnt(3)
    v_mfma_f32_16x16x32_bf16 v[80:83], v[152:155], a[192:195], 0
    v_add_f32 v247, v247, v252
    v_mfma_f32_16x16x32_bf16 v[84:87], v[152:155], a[224:227], 0
    v_add_f32 v247, v247, v253
    v_mfma_f32_16x16x32_bf16 v[88:91], v[152:155], v[184:187], 0
    buffer_load_dwordx4 v235, s[16:19], s30 offen offset:3072 lds
    ds_read_b128 v[172:175], v221 offset:49152
    v_mfma_f32_16x16x32_bf16 v[80:83], v[156:159], a[196:199], v[80:83]
    v_cvt_pk_bf16_f32 v125, v252, v253
    v_mfma_f32_16x16x32_bf16 v[84:87], v[156:159], a[228:231], v[84:87]
    v_fma_f32 v252, v48, s24, v237
    v_fma_f32 v253, v49, s24, v237
    v_mfma_f32_16x16x32_bf16 v[88:91], v[156:159], v[188:191], v[88:91]
    v_exp_f32 v250, v250
    ds_read_b128 v[176:179], v222 offset:49152
    s_waitcnt lgkmcnt(3)
    v_mfma_f32_16x16x32_bf16 v[80:83], v[160:163], a[200:203], v[80:83]
    s_add_u32 m0, s27, 102400
    v_mfma_f32_16x16x32_bf16 v[84:87], v[160:163], a[232:235], v[84:87]
    s_nop 0
    v_mfma_f32_16x16x32_bf16 v[88:91], v[160:163], v[192:195], v[88:91]
    buffer_load_dwordx4 v232, s[16:19], s31 offen offset:0 lds
    v_exp_f32 v251, v251
    ds_read_b128 v[180:183], v223 offset:49152
    v_mfma_f32_16x16x32_bf16 v[80:83], v[164:167], a[204:207], v[80:83]
    v_add_f32 v245, v245, v248
    v_mfma_f32_16x16x32_bf16 v[84:87], v[164:167], a[236:239], v[84:87]
    v_add_f32 v245, v245, v249
    v_mfma_f32_16x16x32_bf16 v[88:91], v[164:167], v[196:199], v[88:91]
    v_cvt_pk_bf16_f32 v118, v248, v249
    ds_read_b128 v[152:155], v216 offset:57344
    s_waitcnt lgkmcnt(3)
    v_mfma_f32_16x16x32_bf16 v[80:83], v[168:171], a[208:211], v[80:83]
    buffer_load_dwordx4 v233, s[16:19], s31 offen offset:1024 lds
    v_mfma_f32_16x16x32_bf16 v[84:87], v[168:171], a[240:243], v[84:87]
    v_fma_f32 v248, v50, s24, v237
    v_fma_f32 v249, v51, s24, v237
    v_mfma_f32_16x16x32_bf16 v[88:91], v[168:171], v[200:203], v[88:91]
    v_exp_f32 v252, v252
    ds_read_b128 v[156:159], v217 offset:57344
    v_mfma_f32_16x16x32_bf16 v[80:83], v[172:175], a[212:215], v[80:83]
    v_exp_f32 v253, v253
    v_mfma_f32_16x16x32_bf16 v[84:87], v[172:175], a[244:247], v[84:87]
    buffer_load_dwordx4 v234, s[16:19], s31 offen offset:2048 lds
    v_mfma_f32_16x16x32_bf16 v[88:91], v[172:175], v[204:207], v[88:91]
    v_add_f32 v245, v245, v250
    v_add_f32 v245, v245, v251
    ds_read_b128 v[160:163], v218 offset:57344
    s_waitcnt lgkmcnt(3)
    v_mfma_f32_16x16x32_bf16 v[80:83], v[176:179], a[216:219], v[80:83]
    v_cvt_pk_bf16_f32 v119, v250, v251
    v_mfma_f32_16x16x32_bf16 v[84:87], v[176:179], a[248:251], v[84:87]
    v_fma_f32 v250, v52, s24, v238
    v_mfma_f32_16x16x32_bf16 v[88:91], v[176:179], v[208:211], v[88:91]
    buffer_load_dwordx4 v235, s[16:19], s31 offen offset:3072 lds
    ds_read_b128 v[164:167], v219 offset:57344
    v_mfma_f32_16x16x32_bf16 v[80:83], v[180:183], a[220:223], v[80:83]
    v_fma_f32 v251, v53, s24, v238
    v_exp_f32 v248, v248
    v_mfma_f32_16x16x32_bf16 v[84:87], v[180:183], a[252:255], v[84:87]
    v_exp_f32 v249, v249
    v_mfma_f32_16x16x32_bf16 v[88:91], v[180:183], v[212:215], v[88:91]
    v_add_f32 v246, v246, v252
    ds_read_b128 v[168:171], v220 offset:57344
    s_waitcnt lgkmcnt(3)
    v_mfma_f32_16x16x32_bf16 v[92:95], v[152:155], a[192:195], 0
    v_add_f32 v246, v246, v253
    v_mfma_f32_16x16x32_bf16 v[96:99], v[152:155], a[224:227], 0
    v_cvt_pk_bf16_f32 v122, v252, v253
    v_mfma_f32_16x16x32_bf16 v[100:103], v[152:155], v[184:187], 0
    v_fma_f32 v252, v54, s24, v238
    v_fma_f32 v253, v55, s24, v238
    ds_read_b128 v[172:175], v221 offset:57344
    v_mfma_f32_16x16x32_bf16 v[92:95], v[156:159], a[196:199], v[92:95]
    v_exp_f32 v250, v250
    v_mfma_f32_16x16x32_bf16 v[96:99], v[156:159], a[228:231], v[96:99]
    v_exp_f32 v251, v251
    v_mfma_f32_16x16x32_bf16 v[100:103], v[156:159], v[188:191], v[100:103]
    v_add_f32 v246, v246, v248
    ds_read_b128 v[176:179], v222 offset:57344
    s_waitcnt lgkmcnt(3)
    v_mfma_f32_16x16x32_bf16 v[92:95], v[160:163], a[200:203], v[92:95]
    v_add_f32 v246, v246, v249
    v_cvt_pk_bf16_f32 v123, v248, v249
    v_mfma_f32_16x16x32_bf16 v[96:99], v[160:163], a[232:235], v[96:99]
    v_exp_f32 v252, v252
    v_mfma_f32_16x16x32_bf16 v[100:103], v[160:163], v[192:195], v[100:103]
    v_exp_f32 v253, v253
    ds_read_b128 v[180:183], v223 offset:57344
    v_mfma_f32_16x16x32_bf16 v[92:95], v[164:167], a[204:207], v[92:95]
    v_add_f32 v247, v247, v250
    v_mfma_f32_16x16x32_bf16 v[96:99], v[164:167], a[236:239], v[96:99]
    v_add_f32 v247, v247, v251
    v_cvt_pk_bf16_f32 v126, v250, v251
    v_mfma_f32_16x16x32_bf16 v[100:103], v[164:167], v[196:199], v[100:103]
    v_add_f32 v247, v247, v252
    ds_read_b64_tr_b16 v[152:153], v224 offset:0
    ds_read_b64_tr_b16 v[154:155], v224 offset:8192
    s_waitcnt lgkmcnt(4)
    v_mfma_f32_16x16x32_bf16 v[92:95], v[168:171], a[208:211], v[92:95]
    v_add_f32 v247, v247, v253
    v_mfma_f32_16x16x32_bf16 v[96:99], v[168:171], a[240:243], v[96:99]
    v_cvt_pk_bf16_f32 v127, v252, v253
    v_mfma_f32_16x16x32_bf16 v[100:103], v[168:171], v[200:203], v[100:103]
    s_add_u32 s28, s28, 32768
    ds_read_b64_tr_b16 v[156:157], v225 offset:0
    ds_read_b64_tr_b16 v[158:159], v225 offset:8192
    v_mfma_f32_16x16x32_bf16 v[92:95], v[172:175], a[212:215], v[92:95]
    s_add_u32 s29, s29, 32768
    s_add_u32 s30, s30, 32768
    v_mfma_f32_16x16x32_bf16 v[96:99], v[172:175], a[244:247], v[96:99]
    s_add_u32 s31, s31, 32768
    v_mfma_f32_16x16x32_bf16 v[100:103], v[172:175], v[204:207], v[100:103]
    v_add_f32 v254, v242, v245
    ds_read_b64_tr_b16 v[160:161], v226 offset:0
    ds_read_b64_tr_b16 v[162:163], v226 offset:8192
    s_waitcnt lgkmcnt(6)
    v_mfma_f32_16x16x32_bf16 v[92:95], v[176:179], a[216:219], v[92:95]
    v_add_f32 v255, v243, v246
    v_mfma_f32_16x16x32_bf16 v[96:99], v[176:179], a[248:251], v[96:99]
    v_add_f32 v1, v244, v247
    v_max3_f32 v5, v254, v255, v1
    v_mfma_f32_16x16x32_bf16 v[100:103], v[176:179], v[208:211], v[100:103]
    v_cmp_nge_f32 vcc, s25, v5
    ds_read_b64_tr_b16 v[164:165], v227 offset:0
    ds_read_b64_tr_b16 v[166:167], v227 offset:8192
    v_mfma_f32_16x16x32_bf16 v[92:95], v[180:183], a[220:223], v[92:95]
    s_nop 4
    s_cbranch_vccnz L_slow_l0
L_back_l0:
    v_mfma_f32_16x16x32_bf16 v[96:99], v[180:183], a[252:255], v[96:99]
    v_add_f32 v239, v239, v254
    v_mfma_f32_16x16x32_bf16 v[100:103], v[180:183], v[212:215], v[100:103]
    v_add_f32 v240, v240, v255
    v_add_f32 v241, v241, v1
    ds_read_b64_tr_b16 v[168:169], v228 offset:0
    ds_read_b64_tr_b16 v[170:171], v228 offset:8192
    s_waitcnt lgkmcnt(6)
    v_mfma_f32_16x16x32_bf16 a[0:3], v[152:155], v[104:107], a[0:3]
    v_mfma_f32_16x16x32_bf16 a[4:7], v[152:155], v[108:111], a[4:7]
    v_fma_f32 v248, v56, s24, v236
    v_mfma_f32_16x16x32_bf16 a[8:11], v[152:155], v[112:115], a[8:11]
    v_fma_f32 v249, v57, s24, v236
    ds_read_b64_tr_b16 v[172:173], v229 offset:0
    ds_read_b64_tr_b16 v[174:175], v229 offset:8192
    v_mfma_f32_16x16x32_bf16 a[12:15], v[156:159], v[104:107], a[12:15]
    v_fma_f32 v250, v58, s24, v236
    v_mfma_f32_16x16x32_bf16 a[16:19], v[156:159], v[108:111], a[16:19]
    v_fma_f32 v251, v59, s24, v236
    v_mfma_f32_16x16x32_bf16 a[20:23], v[156:159], v[112:115], a[20:23]
    v_exp_f32 v248, v248
    ds_read_b64_tr_b16 v[176:177], v230 offset:0
    ds_read_b64_tr_b16 v[178:179], v230 offset:8192
    s_waitcnt lgkmcnt(6)
    v_mfma_f32_16x16x32_bf16 a[24:27], v[160:163], v[104:107], a[24:27]
    v_mfma_f32_16x16x32_bf16 a[28:31], v[160:163], v[108:111], a[28:31]
    v_exp_f32 v249, v249
    v_mfma_f32_16x16x32_bf16 a[32:35], v[160:163], v[112:115], a[32:35]
    v_fma_f32 v252, v60, s24, v237
    ds_read_b64_tr_b16 v[180:181], v231 offset:0
    ds_read_b64_tr_b16 v[182:183], v231 offset:8192
    v_mfma_f32_16x16x32_bf16 a[36:39], v[164:167], v[104:107], a[36:39]
    v_fma_f32 v253, v61, s24, v237
    v_mfma_f32_16x16x32_bf16 a[40:43], v[164:167], v[108:111], a[40:43]
    v_exp_f32 v250, v250
    v_mfma_f32_16x16x32_bf16 a[44:47], v[164:167], v[112:115], a[44:47]
    v_exp_f32 v251, v251
    ds_read_b64_tr_b16 v[152:153], v224 offset:256
    ds_read_b64_tr_b16 v[154:155], v224 offset:8448
    s_waitcnt lgkmcnt(6)
    v_mfma_f32_16x16x32_bf16 a[48:51], v[168:171], v[104:107], a[48:51]
    v_mfma_f32_16x16x32_bf16 a[52:55], v[168:171], v[108:111], a[52:55]
    v_add_f32 v242, v248, v249
    v_mfma_f32_16x16x32_bf16 a[56:59], v[168:171], v[112:115], a[56:59]
    v_cvt_pk_bf16_f32 v128, v248, v249
    ds_read_b64_tr_b16 v[156:157], v225 offset:256
    ds_read_b64_tr_b16 v[158:159], v225 offset:8448
    v_mfma_f32_16x16x32_bf16 a[60:63], v[172:175], v[104:107], a[60:63]
    v_fma_f32 v248, v62, s24, v237
    v_mfma_f32_16x16x32_bf16 a[64:67], v[172:175], v[108:111], a[64:67]
    v_fma_f32 v249, v63, s24, v237
    v_mfma_f32_16x16x32_bf16 a[68:71], v[172:175], v[112:115], a[68:71]
    v_exp_f32 v252, v252
    ds_read_b64_tr_b16 v[160:161], v226 offset:256
    ds_read_b64_tr_b16 v[162:163], v226 offset:8448
    s_waitcnt lgkmcnt(6)
    v_mfma_f32_16x16x32_bf16 a[72:75], v[176:179], v[104:107], a[72:75]
    v_exp_f32 v253, v253
    v_mfma_f32_16x16x32_bf16 a[76:79], v[176:179], v[108:111], a[76:79]
    v_mfma_f32_16x16x32_bf16 a[80:83], v[176:179], v[112:115], a[80:83]
    v_add_f32 v242, v242, v250
    ds_read_b64_tr_b16 v[164:165], v227 offset:256
    ds_read_b64_tr_b16 v[166:167], v227 offset:8448
    v_mfma_f32_16x16x32_bf16 a[84:87], v[180:183], v[104:107], a[84:87]
    v_add_f32 v242, v242, v251
    v_mfma_f32_16x16x32_bf16 a[88:91], v[180:183], v[108:111], a[88:91]
    v_cvt_pk_bf16_f32 v129, v250, v251
    v_mfma_f32_16x16x32_bf16 a[92:95], v[180:183], v[112:115], a[92:95]
    v_fma_f32 v250, v64, s24, v238
    ds_read_b64_tr_b16 v[168:169], v228 offset:256
    ds_read_b64_tr_b16 v[170:171], v228 offset:8448
    s_waitcnt lgkmcnt(6)
    v_mfma_f32_16x16x32_bf16 a[96:99], v[152:155], v[104:107], a[96:99]
    v_fma_f32 v251, v65, s24, v238
    v_mfma_f32_16x16x32_bf16 a[100:103], v[152:155], v[108:111], a[100:103]
    v_mfma_f32_16x16x32_bf16 a[104:107], v[152:155], v[112:115], a[104:107]
    v_exp_f32 v248, v248
    ds_read_b64_tr_b16 v[172:173], v229 offset:256
    ds_read_b64_tr_b16 v[174:175], v229 offset:8448
    v_mfma_f32_16x16x32_bf16 a[108:111], v[156:159], v[104:107], a[108:111]
    v_exp_f32 v249, v249
    v_mfma_f32_16x16x32_bf16 a[112:115], v[156:159], v[108:111], a[112:115]
    v_add_f32 v243, v252, v253
    v_mfma_f32_16x16x32_bf16 a[116:119], v[156:159], v[112:115], a[116:119]
    v_cvt_pk_bf16_f32 v132, v252, v253
    ds_read_b64_tr_b16 v[176:177], v230 offset:256
    ds_read_b64_tr_b16 v[178:179], v230 offset:8448
    s_waitcnt lgkmcnt(6)
    v_mfma_f32_16x16x32_bf16 a[120:123], v[160:163], v[104:107], a[120:123]
    v_fma_f32 v252, v66, s24, v238
    v_mfma_f32_16x16x32_bf16 a[124:127], v[160:163], v[108:111], a[124:127]
    v_fma_f32 v253, v67, s24, v238
    v_mfma_f32_16x16x32_bf16 a[128:131], v[160:163], v[112:115], a[128:131]
    ds_read_b64_tr_b16 v[180:181], v231 offset:256
    ds_read_b64_tr_b16 v[182:183], v231 offset:8448
    v_mfma_f32_16x16x32_bf16 a[132:135], v[164:167], v[104:107], a[132:135]
    v_exp_f32 v250, v250
    v_mfma_f32_16x16x32_bf16 a[136:139], v[164:167], v[108:111], a[136:139]
    v_exp_f32 v251, v251
    v_mfma_f32_16x16x32_bf16 a[140:143], v[164:167], v[112:115], a[140:143]
    v_add_f32 v243, v243, v248
    ds_read_b64_tr_b16 v[152:153], v224 offset:16384
    ds_read_b64_tr_b16 v[154:155], v224 offset:24576
    s_waitcnt lgkmcnt(6)
    v_mfma_f32_16x16x32_bf16 a[144:147], v[168:171], v[104:107], a[144:147]
    v_add_f32 v243, v243, v249
    v_mfma_f32_16x16x32_bf16 a[148:151], v[168:171], v[108:111], a[148:151]
    v_cvt_pk_bf16_f32 v133, v248, v249
    v_mfma_f32_16x16x32_bf16 a[152:155], v[168:171], v[112:115], a[152:155]
    ds_read_b64_tr_b16 v[156:157], v225 offset:16384
    ds_read_b64_tr_b16 v[158:159], v225 offset:24576
    v_mfma_f32_16x16x32_bf16 a[156:159], v[172:175], v[104:107], a[156:159]
    v_fma_f32 v248, v68, s24, v236
    v_mfma_f32_16x16x32_bf16 a[160:163], v[172:175], v[108:111], a[160:163]
    v_fma_f32 v249, v69, s24, v236
    v_mfma_f32_16x16x32_bf16 a[164:167], v[172:175], v[112:115], a[164:167]
    v_exp_f32 v252, v252
    ds_read_b64_tr_b16 v[160:161], v226 offset:16384
    ds_read_b64_tr_b16 v[162:163], v226 offset:24576
    s_waitcnt lgkmcnt(6)
    v_mfma_f32_16x16x32_bf16 a[168:171], v[176:179], v[104:107], a[168:171]
    v_exp_f32 v253, v253
    v_mfma_f32_16x16x32_bf16 a[172:175], v[176:179], v[108:111], a[172:175]
    v_add_f32 v244, v250, v251
    v_mfma_f32_16x16x32_bf16 a[176:179], v[176:179], v[112:115], a[176:179]
    ds_read_b64_tr_b16 v[164:165], v227 offset:16384
    ds_read_b64_tr_b16 v[166:167], v227 offset:24576
    v_mfma_f32_16x16x32_bf16 a[180:183], v[180:183], v[104:107], a[180:183]
    v_cvt_pk_bf16_f32 v136, v250, v251
    v_mfma_f32_16x16x32_bf16 a[184:187], v[180:183], v[108:111], a[184:187]
    v_fma_f32 v250, v70, s24, v236
    v_mfma_f32_16x16x32_bf16 a[188:191], v[180:183], v[112:115], a[188:191]
    v_fma_f32 v251, v71, s24, v236
    ds_read_b64_tr_b16 v[168:169], v228 offset:16384
    ds_read_b64_tr_b16 v[170:171], v228 offset:24576
    s_waitcnt lgkmcnt(6)
    v_mfma_f32_16x16x32_bf16 a[0:3], v[152:155], v[116:119], a[0:3]
    v_exp_f32 v248, v248
    v_mfma_f32_16x16x32_bf16 a[4:7], v[152:155], v[120:123], a[4:7]
    v_exp_f32 v249, v249
    v_mfma_f32_16x16x32_bf16 a[8:11], v[152:155], v[124:127], a[8:11]
    v_add_f32 v244, v244, v252
    ds_read_b64_tr_b16 v[172:173], v229 offset:16384
    ds_read_b64_tr_b16 v[174:175], v229 offset:24576
    v_mfma_f32_16x16x32_bf16 a[12:15], v[156:159], v[116:119], a[12:15]
    v_mfma_f32_16x16x32_bf16 a[16:19], v[156:159], v[120:123], a[16:19]
    v_add_f32 v244, v244, v253
    v_mfma_f32_16x16x32_bf16 a[20:23], v[156:159], v[124:127], a[20:23]
    v_cvt_pk_bf16_f32 v137, v252, v253
    ds_read_b64_tr_b16 v[176:177], v230 offset:16384
    ds_read_b64_tr_b16 v[178:179], v230 offset:24576
    s_waitcnt lgkmcnt(6)
    v_mfma_f32_16x16x32_bf16 a[24:27], v[160:163], v[116:119], a[24:27]
    v_fma_f32 v252, v72, s24, v237
    v_mfma_f32_16x16x32_bf16 a[28:31], v[160:163], v[120:123], a[28:31]
    v_fma_f32 v253, v73, s24, v237
    v_mfma_f32_16x16x32_bf16 a[32:35], v[160:163], v[124:127], a[32:35]
    v_exp_f32 v250, v250
    ds_read_b64_tr_b16 v[180:181], v231 offset:16384
    ds_read_b64_tr_b16 v[182:183], v231 offset:24576
    v_mfma_f32_16x16x32_bf16 a[36:39], v[164:167], v[116:119], a[36:39]
    v_mfma_f32_16x16x32_bf16 a[40:43], v[164:167], v[120:123], a[40:43]
    v_exp_f32 v251, v251
    v_mfma_f32_16x16x32_bf16 a[44:47], v[164:167], v[124:127], a[44:47]
    v_add_f32 v242, v242, v248
    ds_read_b64_tr_b16 v[152:153], v224 offset:16640
    ds_read_b64_tr_b16 v[154:155], v224 offset:24832
    s_waitcnt lgkmcnt(6)
    v_mfma_f32_16x16x32_bf16 a[48:51], v[168:171], v[116:119], a[48:51]
    v_add_f32 v242, v242, v249
    v_mfma_f32_16x16x32_bf16 a[52:55], v[168:171], v[120:123], a[52:55]
    v_cvt_pk_bf16_f32 v130, v248, v249
    v_mfma_f32_16x16x32_bf16 a[56:59], v[168:171], v[124:127], a[56:59]
    v_fma_f32 v248, v74, s24, v237
    ds_read_b64_tr_b16 v[156:157], v225 offset:16640
    ds_read_b64_tr_b16 v[158:159], v225 offset:24832
    v_mfma_f32_16x16x32_bf16 a[60:63], v[172:175], v[116:119], a[60:63]
    v_fma_f32 v249, v75, s24, v237
    v_mfma_f32_16x16x32_bf16 a[64:67], v[172:175], v[120:123], a[64:67]
    v_mfma_f32_16x16x32_bf16 a[68:71], v[172:175], v[124:127], a[68:71]
    v_exp_f32 v252, v252
    ds_read_b64_tr_b16 v[160:161], v226 offset:16640
    ds_read_b64_tr_b16 v[162:163], v226 offset:24832
    s_waitcnt lgkmcnt(6)
    v_mfma_f32_16x16x32_bf16 a[72:75], v[176:179], v[116:119], a[72:75]
    v_exp_f32 v253, v253
    v_mfma_f32_16x16x32_bf16 a[76:79], v[176:179], v[120:123], a[76:79]
    v_add_f32 v242, v242, v250
    v_mfma_f32_16x16x32_bf16 a[80:83], v[176:179], v[124:127], a[80:83]
    v_add_f32 v242, v242, v251
    ds_read_b64_tr_b16 v[164:165], v227 offset:16640
    ds_read_b64_tr_b16 v[166:167], v227 offset:24832
    v_mfma_f32_16x16x32_bf16 a[84:87], v[180:183], v[116:119], a[84:87]
    v_cvt_pk_bf16_f32 v131, v250, v251
    v_mfma_f32_16x16x32_bf16 a[88:91], v[180:183], v[120:123], a[88:91]
    v_mfma_f32_16x16x32_bf16 a[92:95], v[180:183], v[124:127], a[92:95]
    v_fma_f32 v250, v76, s24, v238
    ds_read_b64_tr_b16 v[168:169], v228 offset:16640
    ds_read_b64_tr_b16 v[170:171], v228 offset:24832
    s_waitcnt lgkmcnt(6)
    v_mfma_f32_16x16x32_bf16 a[96:99], v[152:155], v[116:119], a[96:99]
    v_fma_f32 v251, v77, s24, v238
    v_mfma_f32_16x16x32_bf16 a[100:103], v[152:155], v[120:123], a[100:103]
    v_exp_f32 v248, v248
    v_mfma_f32_16x16x32_bf16 a[104:107], v[152:155], v[124:127], a[104:107]
    v_exp_f32 v249, v249
    ds_read_b64_tr_b16 v[172:173], v229 offset:16640
    ds_read_b64_tr_b16 v[174:175], v229 offset:24832
    v_mfma_f32_16x16x32_bf16 a[108:111], v[156:159], v[116:119], a[108:111]
    v_add_f32 v243, v243, v252
    v_mfma_f32_16x16x32_bf16 a[112:115], v[156:159], v[120:123], a[112:115]
    v_mfma_f32_16x16x32_bf16 a[116:119], v[156:159], v[124:127], a[116:119]
    v_add_f32 v243, v243, v253
    ds_read_b64_tr_b16 v[176:177], v230 offset:16640
    ds_read_b64_tr_b16 v[178:179], v230 offset:24832
    s_waitcnt lgkmcnt(6)
    v_mfma_f32_16x16x32_bf16 a[120:123], v[160:163], v[116:119], a[120:123]
    v_cvt_pk_bf16_f32 v134, v252, v253
    v_mfma_f32_16x16x32_bf16 a[124:127], v[160:163], v[120:123], a[124:127]
    v_fma_f32 v252, v78, s24, v238
    v_mfma_f32_16x16x32_bf16 a[128:131], v[160:163], v[124:127], a[128:131]
    v_fma_f32 v253, v79, s24, v238
    ds_read_b64_tr_b16 v[180:181], v231 offset:16640
    ds_read_b64_tr_b16 v[182:183], v231 offset:24832
    v_mfma_f32_16x16x32_bf16 a[132:135], v[164:167], v[116:119], a[132:135]
    v_exp_f32 v250, v250
    v_mfma_f32_16x16x32_bf16 a[136:139], v[164:167], v[120:123], a[136:139]
    v_exp_f32 v251, v251
    v_mfma_f32_16x16x32_bf16 a[140:143], v[164:167], v[124:127], a[140:143]
    s_waitcnt lgkmcnt(4)
    v_mfma_f32_16x16x32_bf16 a[144:147], v[168:171], v[116:119], a[144:147]
    v_add_f32 v243, v243, v248
    v_mfma_f32_16x16x32_bf16 a[148:151], v[168:171], v[120:123], a[148:151]
    v_add_f32 v243, v243, v249
    v_mfma_f32_16x16x32_bf16 a[152:155], v[168:171], v[124:127], a[152:155]
    v_cvt_pk_bf16_f32 v135, v248, v249
    v_mfma_f32_16x16x32_bf16 a[156:159], v[172:175], v[116:119], a[156:159]
    v_exp_f32 v252, v252
    v_mfma_f32_16x16x32_bf16 a[160:163], v[172:175], v[120:123], a[160:163]
    v_exp_f32 v253, v253
    v_mfma_f32_16x16x32_bf16 a[164:167], v[172:175], v[124:127], a[164:167]
    s_waitcnt lgkmcnt(0)
    v_mfma_f32_16x16x32_bf16 a[168:171], v[176:179], v[116:119], a[168:171]
    v_add_f32 v244, v244, v250
    v_mfma_f32_16x16x32_bf16 a[172:175], v[176:179], v[120:123], a[172:175]
    v_add_f32 v244, v244, v251
    v_mfma_f32_16x16x32_bf16 a[176:179], v[176:179], v[124:127], a[176:179]
    v_cvt_pk_bf16_f32 v138, v250, v251
    v_mfma_f32_16x16x32_bf16 a[180:183], v[180:183], v[116:119], a[180:183]
    v_add_f32 v244, v244, v252
    v_mfma_f32_16x16x32_bf16 a[184:187], v[180:183], v[120:123], a[184:187]
    v_add_f32 v244, v244, v253
    v_mfma_f32_16x16x32_bf16 a[188:191], v[180:183], v[124:127], a[188:191]
    v_cvt_pk_bf16_f32 v139, v252, v253
    s_waitcnt vmcnt(0)
    s_barrier
    ds_read_b128 v[152:155], v216 offset:0
    ds_read_b128 v[156:159], v217 offset:0
    ds_read_b128 v[160:163], v218 offset:0
    ds_read_b128 v[164:167], v219 offset:0
    ds_read_b128 v[168:171], v220 offset:0
    s_waitcnt lgkmcnt(3)
    v_mfma_f32_16x16x32_bf16 v[8:11], v[152:155], a[192:195], 0
    s_add_u32 m0, s27, 32768
    v_mfma_f32_16x16x32_bf16 v[12:15], v[152:155], a[224:227], 0
    s_nop 0
    v_mfma_f32_16x16x32_bf16 v[16:19], v[152:155], v[184:187], 0
    buffer_load_dwordx4 v232, s[12:15], s28 offen offset:0 lds
    ds_read_b128 v[172:175], v221 offset:0
    v_mfma_f32_16x16x32_bf16 v[8:11], v[156:159], a[196:199], v[8:11]
    v_fma_f32 v248, v80, s24, v236
    v_mfma_f32_16x16x32_bf16 v[12:15], v[156:159], a[228:231], v[12:15]
    v_fma_f32 v249, v81, s24, v236
    v_fma_f32 v250, v82, s24, v236
    v_mfma_f32_16x16x32_bf16 v[16:19], v[156:159], v[188:191], v[16:19]
    v_fma_f32 v251, v83, s24, v236
    ds_read_b128 v[176:179], v222 offset:0
    s_waitcnt lgkmcnt(3)
    v_mfma_f32_16x16x32_bf16 v[8:11], v[160:163], a[200:203], v[8:11]
    buffer_load_dwordx4 v233, s[12:15], s28 offen offset:1024 lds
    v_mfma_f32_16x16x32_bf16 v[12:15], v[160:163], a[232:235], v[12:15]
    v_exp_f32 v248, v248
    v_mfma_f32_16x16x32_bf16 v[16:19], v[160:163], v[192:195], v[16:19]
    v_exp_f32 v249, v249
    v_fma_f32 v252, v84, s24, v237
    ds_read_b128 v[180:183], v223 offset:0
    v_mfma_f32_16x16x32_bf16 v[8:11], v[164:167], a[204:207], v[8:11]
    v_fma_f32 v253, v85, s24, v237
    v_mfma_f32_16x16x32_bf16 v[12:15], v[164:167], a[236:239], v[12:15]
    buffer_load_dwordx4 v234, s[12:15], s28 offen offset:2048 lds
    v_mfma_f32_16x16x32_bf16 v[16:19], v[164:167], v[196:199], v[16:19]
    v_exp_f32 v250, v250
    ds_read_b128 v[152:155], v216 offset:8192
    s_waitcnt lgkmcnt(3)
    v_mfma_f32_16x16x32_bf16 v[8:11], v[168:171], a[208:211], v[8:11]
    v_exp_f32 v251, v251
    v_mfma_f32_16x16x32_bf16 v[12:15], v[168:171], a[240:243], v[12:15]
    v_add_f32 v245, v248, v249
    v_cvt_pk_bf16_f32 v140, v248, v249
    v_mfma_f32_16x16x32_bf16 v[16:19], v[168:171], v[200:203], v[16:19]
    buffer_load_dwordx4 v235, s[12:15], s28 offen offset:3072 lds
    ds_read_b128 v[156:159], v217 offset:8192
    v_mfma_f32_16x16x32_bf16 v[8:11], v[172:175], a[212:215], v[8:11]
    v_fma_f32 v248, v86, s24, v237
    v_mfma_f32_16x16x32_bf16 v[12:15], v[172:175], a[244:247], v[12:15]
    v_fma_f32 v249, v87, s24, v237
    v_mfma_f32_16x16x32_bf16 v[16:19], v[172:175], v[204:207], v[16:19]
    v_exp_f32 v252, v252
    v_exp_f32 v253, v253
    ds_read_b128 v[160:163], v218 offset:8192
    s_waitcnt lgkmcnt(3)
    v_mfma_f32_16x16x32_bf16 v[8:11], v[176:179], a[216:219], v[8:11]
    s_add_u32 m0, s27, 36864
    v_mfma_f32_16x16x32_bf16 v[12:15], v[176:179], a[248:251], v[12:15]
    s_nop 0
    v_mfma_f32_16x16x32_bf16 v[16:19], v[176:179], v[208:211], v[16:19]
    buffer_load_dwordx4 v232, s[12:15], s29 offen offset:0 lds
    ds_read_b128 v[164:167], v219 offset:8192
    v_mfma_f32_16x16x32_bf16 v[8:11], v[180:183], a[220:223], v[8:11]
    v_add_f32 v245, v245, v250
    v_add_f32 v245, v245, v251
    v_mfma_f32_16x16x32_bf16 v[12:15], v[180:183], a[252:255], v[12:15]
    v_cvt_pk_bf16_f32 v141, v250, v251
    v_mfma_f32_16x16x32_bf16 v[16:19], v[180:183], v[212:215], v[16:19]
    v_fma_f32 v250, v88, s24, v238
    ds_read_b128 v[168:171], v220 offset:8192
    s_waitcnt lgkmcnt(3)
    v_mfma_f32_16x16x32_bf16 v[20:23], v[152:155], a[192:195], 0
    buffer_load_dwordx4 v233, s[12:15], s29 offen offset:1024 lds
    v_mfma_f32_16x16x32_bf16 v[24:27], v[152:155], a[224:227], 0
    v_fma_f32 v251, v89, s24, v238
    v_mfma_f32_16x16x32_bf16 v[28:31], v[152:155], v[184:187], 0
    v_exp_f32 v248, v248
    v_exp_f32 v249, v249
    ds_read_b128 v[172:175], v221 offset:8192
    v_mfma_f32_16x16x32_bf16 v[20:23], v[156:159], a[196:199], v[20:23]
    v_add_f32 v246, v252, v253
    v_mfma_f32_16x16x32_bf16 v[24:27], v[156:159], a[228:231], v[24:27]
    buffer_load_dwordx4 v234, s[12:15], s29 offen offset:2048 lds
    v_mfma_f32_16x16x32_bf16 v[28:31], v[156:159], v[188:191], v[28:31]
    v_cvt_pk_bf16_f32 v144, v252, v253
    ds_read_b128 v[176:179], v222 offset:8192
    s_waitcnt lgkmcnt(3)
    v_mfma_f32_16x16x32_bf16 v[20:23], v[160:163], a[200:203], v[20:23]
    v_fma_f32 v252, v90, s24, v238
    v_fma_f32 v253, v91, s24, v238
    v_mfma_f32_16x16x32_bf16 v[24:27], v[160:163], a[232:235], v[24:27]
    v_exp_f32 v250, v250
    v_mfma_f32_16x16x32_bf16 v[28:31], v[160:163], v[192:195], v[28:31]
    buffer_load_dwordx4 v235, s[12:15], s29 offen offset:3072 lds
    ds_read_b128 v[180:183], v223 offset:8192
    v_mfma_f32_16x16x32_bf16 v[20:23], v[164:167], a[204:207], v[20:23]
    v_exp_f32 v251, v251
    v_mfma_f32_16x16x32_bf16 v[24:27], v[164:167], a[236:239], v[24:27]
    v_add_f32 v246, v246, v248
    v_add_f32 v246, v246, v249
    v_mfma_f32_16x16x32_bf16 v[28:31], v[164:167], v[196:199], v[28:31]
    v_cvt_pk_bf16_f32 v145, v248, v249
    ds_read_b128 v[152:155], v216 offset:16384
    s_waitcnt lgkmcnt(3)
    v_mfma_f32_16x16x32_bf16 v[20:23], v[168:171], a[208:211], v[20:23]
    s_add_u32 m0, s27, 65536
    v_mfma_f32_16x16x32_bf16 v[24:27], v[168:171], a[240:243], v[24:27]
    s_nop 0
    v_mfma_f32_16x16x32_bf16 v[28:31], v[168:171], v[200:203], v[28:31]
    buffer_load_dwordx4 v232, s[16:19], s30 offen offset:0 lds
    ds_read_b128 v[156:159], v217 offset:16384
    v_mfma_f32_16x16x32_bf16 v[20:23], v[172:175], a[212:215], v[20:23]
    v_fma_f32 v248, v92, s24, v236
    v_fma_f32 v249, v93, s24, v236
    v_mfma_f32_16x16x32_bf16 v[24:27], v[172:175], a[244:247], v[24:27]
    v_exp_f32 v252, v252
    v_mfma_f32_16x16x32_bf16 v[28:31], v[172:175], v[204:207], v[28:31]
    v_exp_f32 v253, v253
    ds_read_b128 v[160:163], v218 offset:16384
    s_waitcnt lgkmcnt(3)
    v_mfma_f32_16x16x32_bf16 v[20:23], v[176:179], a[216:219], v[20:23]
    buffer_load_dwordx4 v233, s[16:19], s30 offen offset:1024 lds
    v_mfma_f32_16x16x32_bf16 v[24:27], v[176:179], a[248:251], v[24:27]
    v_add_f32 v247, v250, v251
    v_cvt_pk_bf16_f32 v148, v250, v251
    v_mfma_f32_16x16x32_bf16 v[28:31], v[176:179], v[208:211], v[28:31]
    v_fma_f32 v250, v94, s24, v236
    ds_read_b128 v[164:167], v219 offset:16384
    v_mfma_f32_16x16x32_bf16 v[20:23], v[180:183], a[220:223], v[20:23]
    v_fma_f32 v251, v95, s24, v236
    v_mfma_f32_16x16x32_bf16 v[24:27], v[180:183], a[252:255], v[24:27]
    buffer_load_dwordx4 v234, s[16:19], s30 offen offset:2048 lds
    v_mfma_f32_16x16x32_bf16 v[28:31], v[180:183], v[212:215], v[28:31]
    v_exp_f32 v248, v248
    v_exp_f32 v249, v249
    ds_read_b128 v[168:171], v220 offset:16384
    s_waitcnt lgkmcnt(3)
    v_mfma_f32_16x16x32_bf16 v[32:35], v[152:155], a[192:195], 0
    v_add_f32 v247, v247, v252
    v_mfma_f32_16x16x32_bf16 v[36:39], v[152:155], a[224:227], 0
    v_add_f32 v247, v247, v253
    v_mfma_f32_16x16x32_bf16 v[40:43], v[152:155], v[184:187], 0
    buffer_load_dwordx4 v235, s[16:19], s30 offen offset:3072 lds
    ds_read_b128 v[172:175], v221 offset:16384
    v_mfma_f32_16x16x32_bf16 v[32:35], v[156:159], a[196:199], v[32:35]
    v_cvt_pk_bf16_f32 v149, v252, v253
    v_mfma_f32_16x16x32_bf16 v[36:39], v[156:159], a[228:231], v[36:39]
    v_fma_f32 v252, v96, s24, v237
    v_fma_f32 v253, v97, s24, v237
    v_mfma_f32_16x16x32_bf16 v[40:43], v[156:159], v[188:191], v[40:43]
    v_exp_f32 v250, v250
    ds_read_b128 v[176:179], v222 offset:16384
    s_waitcnt lgkmcnt(3)
    v_mfma_f32_16x16x32_bf16 v[32:35], v[160:163], a[200:203], v[32:35]
    s_add_u32 m0, s27, 69632
    v_mfma_f32_16x16x32_bf16 v[36:39], v[160:163], a[232:235], v[36:39]
    s_nop 0
    v_mfma_f32_16x16x32_bf16 v[40:43], v[160:163], v[192:195], v[40:43]
    buffer_load_dwordx4 v232, s[16:19], s31 offen offset:0 lds
    v_exp_f32 v251, v251
    ds_read_b128 v[180:183], v223 offset:16384
    v_mfma_f32_16x16x32_bf16 v[32:35], v[164:167], a[204:207], v[32:35]
    v_add_f32 v245, v245, v248
    v_mfma_f32_16x16x32_bf16 v[36:39], v[164:167], a[236:239], v[36:39]
    v_add_f32 v245, v245, v249
    v_mfma_f32_16x16x32_bf16 v[40:43], v[164:167], v[196:199], v[40:43]
    v_cvt_pk_bf16_f32 v142, v248, v249
    ds_read_b128 v[152:155], v216 offset:24576
    s_waitcnt lgkmcnt(3)
    v_mfma_f32_16x16x32_bf16 v[32:35], v[168:171], a[208:211], v[32:35]
    buffer_load_dwordx4 v233, s[16:19], s31 offen offset:1024 lds
    v_mfma_f32_16x16x32_bf16 v[36:39], v[168:171], a[240:243], v[36:39]
    v_fma_f32 v248, v98, s24, v237
    v_fma_f32 v249, v99, s24, v237
    v_mfma_f32_16x16x32_bf16 v[40:43], v[168:171], v[200:203], v[40:43]
    v_exp_f32 v252, v252
    ds_read_b128 v[156:159], v217 offset:24576
    v_mfma_f32_16x16x32_bf16 v[32:35], v[172:175], a[212:215], v[32:35]
    v_exp_f32 v253, v253
    v_mfma_f32_16x16x32_bf16 v[36:39], v[172:175], a[244:247], v[36:39]
    buffer_load_dwordx4 v234, s[16:19], s31 offen offset:2048 lds
    v_mfma_f32_16x16x32_bf16 v[40:43], v[172:175], v[204:207], v[40:43]
    v_add_f32 v245, v245, v250
    v_add_f32 v245, v245, v251
    ds_read_b128 v[160:163], v218 offset:24576
    s_waitcnt lgkmcnt(3)
    v_mfma_f32_16x16x32_bf16 v[32:35], v[176:179], a[216:219], v[32:35]
    v_cvt_pk_bf16_f32 v143, v250, v251
    v_mfma_f32_16x16x32_bf16 v[36:39], v[176:179], a[248:251], v[36:39]
    v_fma_f32 v250, v100, s24, v238
    v_mfma_f32_16x16x32_bf16 v[40:43], v[176:179], v[208:211], v[40:43]
    buffer_load_dwordx4 v235, s[16:19], s31 offen offset:3072 lds
    ds_read_b128 v[164:167], v219 offset:24576
    v_mfma_f32_16x16x32_bf16 v[32:35], v[180:183], a[220:223], v[32:35]
    v_fma_f32 v251, v101, s24, v238
    v_exp_f32 v248, v248
    v_mfma_f32_16x16x32_bf16 v[36:39], v[180:183], a[252:255], v[36:39]
    v_exp_f32 v249, v249
    v_mfma_f32_16x16x32_bf16 v[40:43], v[180:183], v[212:215], v[40:43]
    v_add_f32 v246, v246, v252
    ds_read_b128 v[168:171], v220 offset:24576
    s_waitcnt lgkmcnt(3)
    v_mfma_f32_16x16x32_bf16 v[44:47], v[152:155], a[192:195], 0
    v_add_f32 v246, v246, v253
    v_mfma_f32_16x16x32_bf16 v[48:51], v[152:155], a[224:227], 0
    v_cvt_pk_bf16_f32 v146, v252, v253
    v_mfma_f32_16x16x32_bf16 v[52:55], v[152:155], v[184:187], 0
    v_fma_f32 v252, v102, s24, v238
    v_fma_f32 v253, v103, s24, v238
    ds_read_b128 v[172:175], v221 offset:24576
    v_mfma_f32_16x16x32_bf16 v[44:47], v[156:159], a[196:199], v[44:47]
    v_exp_f32 v250, v250
    v_mfma_f32_16x16x32_bf16 v[48:51], v[156:159], a[228:231], v[48:51]
    v_exp_f32 v251, v251
    v_mfma_f32_16x16x32_bf16 v[52:55], v[156:159], v[188:191], v[52:55]
    v_add_f32 v246, v246, v248
    ds_read_b128 v[176:179], v222 offset:24576
    s_waitcnt lgkmcnt(3)
    v_mfma_f32_16x16x32_bf16 v[44:47], v[160:163], a[200:203], v[44:47]
    v_add_f32 v246, v246, v249
    v_cvt_pk_bf16_f32 v147, v248, v249
    v_mfma_f32_16x16x32_bf16 v[48:51], v[160:163], a[232:235], v[48:51]
    v_exp_f32 v252, v252
    v_mfma_f32_16x16x32_bf16 v[52:55], v[160:163], v[192:195], v[52:55]
    v_exp_f32 v253, v253
    ds_read_b128 v[180:183], v223 offset:24576
    v_mfma_f32_16x16x32_bf16 v[44:47], v[164:167], a[204:207], v[44:47]
    v_add_f32 v247, v247, v250
    v_mfma_f32_16x16x32_bf16 v[48:51], v[164:167], a[236:239], v[48:51]
    v_add_f32 v247, v247, v251
    v_cvt_pk_bf16_f32 v150, v250, v251
    v_mfma_f32_16x16x32_bf16 v[52:55], v[164:167], v[196:199], v[52:55]
    v_add_f32 v247, v247, v252
    ds_read_b64_tr_b16 v[152:153], v224 offset:32768
    ds_read_b64_tr_b16 v[154:155], v224 offset:40960
    s_waitcnt lgkmcnt(4)
    v_mfma_f32_16x16x32_bf16 v[44:47], v[168:171], a[208:211], v[44:47]
    v_add_f32 v247, v247, v253
    v_mfma_f32_16x16x32_bf16 v[48:51], v[168:171], a[240:243], v[48:51]
    v_cvt_pk_bf16_f32 v151, v252, v253
    v_mfma_f32_16x16x32_bf16 v[52:55], v[168:171], v[200:203], v[52:55]
    s_add_u32 s28, s28, 32768
    ds_read_b64_tr_b16 v[156:157], v225 offset:32768
    ds_read_b64_tr_b16 v[158:159], v225 offset:40960
    v_mfma_f32_16x16x32_bf16 v[44:47], v[172:175], a[212:215], v[44:47]
    s_add_u32 s29, s29, 32768
    s_add_u32 s30, s30, 32768
    v_mfma_f32_16x16x32_bf16 v[48:51], v[172:175], a[244:247], v[48:51]
    s_add_u32 s31, s31, 32768
    v_mfma_f32_16x16x32_bf16 v[52:55], v[172:175], v[204:207], v[52:55]
    v_add_f32 v254, v242, v245
    ds_read_b64_tr_b16 v[160:161], v226 offset:32768
    ds_read_b64_tr_b16 v[162:163], v226 offset:40960
    s_waitcnt lgkmcnt(6)
    v_mfma_f32_16x16x32_bf16 v[44:47], v[176:179], a[216:219], v[44:47]
    v_add_f32 v255, v243, v246
    v_mfma_f32_16x16x32_bf16 v[48:51], v[176:179], a[248:251], v[48:51]
    v_add_f32 v1, v244, v247
    v_max3_f32 v5, v254, v255, v1
    v_mfma_f32_16x16x32_bf16 v[52:55], v[176:179], v[208:211], v[52:55]
    v_cmp_nge_f32 vcc, s25, v5
    ds_read_b64_tr_b16 v[164:165], v227 offset:32768
    ds_read_b64_tr_b16 v[166:167], v227 offset:40960
    v_mfma_f32_16x16x32_bf16 v[44:47], v[180:183], a[220:223], v[44:47]
    s_nop 4
    s_cbranch_vccnz L_slow_l1
L_back_l1:
    v_mfma_f32_16x16x32_bf16 v[48:51], v[180:183], a[252:255], v[48:51]
    v_add_f32 v239, v239, v254
    v_mfma_f32_16x16x32_bf16 v[52:55], v[180:183], v[212:215], v[52:55]
    v_add_f32 v240, v240, v255
    v_add_f32 v241, v241, v1
    ds_read_b64_tr_b16 v[168:169], v228 offset:32768
    ds_read_b64_tr_b16 v[170:171], v228 offset:40960
    s_waitcnt lgkmcnt(6)
    v_mfma_f32_16x16x32_bf16 a[0:3], v[152:155], v[128:131], a[0:3]
    v_mfma_f32_16x16x32_bf16 a[4:7], v[152:155], v[132:135], a[4:7]
    v_fma_f32 v248, v8, s24, v236
    v_mfma_f32_16x16x32_bf16 a[8:11], v[152:155], v[136:139], a[8:11]
    v_fma_f32 v249, v9, s24, v236
    ds_read_b64_tr_b16 v[172:173], v229 offset:32768
    ds_read_b64_tr_b16 v[174:175], v229 offset:40960
    v_mfma_f32_16x16x32_bf16 a[12:15], v[156:159], v[128:131], a[12:15]
    v_fma_f32 v250, v10, s24, v236
    v_mfma_f32_16x16x32_bf16 a[16:19], v[156:159], v[132:135], a[16:19]
    v_fma_f32 v251, v11, s24, v236
    v_mfma_f32_16x16x32_bf16 a[20:23], v[156:159], v[136:139], a[20:23]
    v_exp_f32 v248, v248
    ds_read_b64_tr_b16 v[176:177], v230 offset:32768
    ds_read_b64_tr_b16 v[178:179], v230 offset:40960
    s_waitcnt lgkmcnt(6)
    v_mfma_f32_16x16x32_bf16 a[24:27], v[160:163], v[128:131], a[24:27]
    v_mfma_f32_16x16x32_bf16 a[28:31], v[160:163], v[132:135], a[28:31]
    v_exp_f32 v249, v249
    v_mfma_f32_16x16x32_bf16 a[32:35], v[160:163], v[136:139], a[32:35]
    v_fma_f32 v252, v12, s24, v237
    ds_read_b64_tr_b16 v[180:181], v231 offset:32768
    ds_read_b64_tr_b16 v[182:183], v231 offset:40960
    v_mfma_f32_16x16x32_bf16 a[36:39], v[164:167], v[128:131], a[36:39]
    v_fma_f32 v253, v13, s24, v237
    v_mfma_f32_16x16x32_bf16 a[40:43], v[164:167], v[132:135], a[40:43]
    v_exp_f32 v250, v250
    v_mfma_f32_16x16x32_bf16 a[44:47], v[164:167], v[136:139], a[44:47]
    v_exp_f32 v251, v251
    ds_read_b64_tr_b16 v[152:153], v224 offset:33024
    ds_read_b64_tr_b16 v[154:155], v224 offset:41216
    s_waitcnt lgkmcnt(6)
    v_mfma_f32_16x16x32_bf16 a[48:51], v[168:171], v[128:131], a[48:51]
    v_mfma_f32_16x16x32_bf16 a[52:55], v[168:171], v[132:135], a[52:55]
    v_add_f32 v242, v248, v249
    v_mfma_f32_16x16x32_bf16 a[56:59], v[168:171], v[136:139], a[56:59]
    v_cvt_pk_bf16_f32 v104, v248, v249
    ds_read_b64_tr_b16 v[156:157], v225 offset:33024
    ds_read_b64_tr_b16 v[158:159], v225 offset:41216
    v_mfma_f32_16x16x32_bf16 a[60:63], v[172:175], v[128:131], a[60:63]
    v_fma_f32 v248, v14, s24, v237
    v_mfma_f32_16x16x32_bf16 a[64:67], v[172:175], v[132:135], a[64:67]
    v_fma_f32 v249, v15, s24, v237
    v_mfma_f32_16x16x32_bf16 a[68:71], v[172:175], v[136:139], a[68:71]
    v_exp_f32 v252, v252
    ds_read_b64_tr_b16 v[160:161], v226 offset:33024
    ds_read_b64_tr_b16 v[162:163], v226 offset:41216
    s_waitcnt lgkmcnt(6)
    v_mfma_f32_16x16x32_bf16 a[72:75], v[176:179], v[128:131], a[72:75]
    v_exp_f32 v253, v253
    v_mfma_f32_16x16x32_bf16 a[76:79], v[176:179], v[132:135], a[76:79]
    v_mfma_f32_16x16x32_bf16 a[80:83], v[176:179], v[136:139], a[80:83]
    v_add_f32 v242, v242, v250
    ds_read_b64_tr_b16 v[164:165], v227 offset:33024
    ds_read_b64_tr_b16 v[166:167], v227 offset:41216
    v_mfma_f32_16x16x32_bf16 a[84:87], v[180:183], v[128:131], a[84:87]
    v_add_f32 v242, v242, v251
    v_mfma_f32_16x16x32_bf16 a[88:91], v[180:183], v[132:135], a[88:91]
    v_cvt_pk_bf16_f32 v105, v250, v251
    v_mfma_f32_16x16x32_bf16 a[92:95], v[180:183], v[136:139], a[92:95]
    v_fma_f32 v250, v16, s24, v238
    ds_read_b64_tr_b16 v[168:169], v228 offset:33024
    ds_read_b64_tr_b16 v[170:171], v228 offset:41216
    s_waitcnt lgkmcnt(6)
    v_mfma_f32_16x16x32_bf16 a[96:99], v[152:155], v[128:131], a[96:99]
    v_fma_f32 v251, v17, s24, v238
    v_mfma_f32_16x16x32_bf16 a[100:103], v[152:155], v[132:135], a[100:103]
    v_mfma_f32_16x16x32_bf16 a[104:107], v[152:155], v[136:139], a[104:107]
    v_exp_f32 v248, v248
    ds_read_b64_tr_b16 v[172:173], v229 offset:33024
    ds_read_b64_tr_b16 v[174:175], v229 offset:41216
    v_mfma_f32_16x16x32_bf16 a[108:111], v[156:159], v[128:131], a[108:111]
    v_exp_f32 v249, v249
    v_mfma_f32_16x16x32_bf16 a[112:115], v[156:159], v[132:135], a[112:115]
    v_add_f32 v243, v252, v253
    v_mfma_f32_16x16x32_bf16 a[116:119], v[156:159], v[136:139], a[116:119]
    v_cvt_pk_bf16_f32 v108, v252, v253
    ds_read_b64_tr_b16 v[176:177], v230 offset:33024
    ds_read_b64_tr_b16 v[178:179], v230 offset:41216
    s_waitcnt lgkmcnt(6)
    v_mfma_f32_16x16x32_bf16 a[120:123], v[160:163], v[128:131], a[120:123]
    v_fma_f32 v252, v18, s24, v238
    v_mfma_f32_16x16x32_bf16 a[124:127], v[160:163], v[132:135], a[124:127]
    v_fma_f32 v253, v19, s24, v238
    v_mfma_f32_16x16x32_bf16 a[128:131], v[160:163], v[136:139], a[128:131]
    ds_read_b64_tr_b16 v[180:181], v231 offset:33024
    ds_read_b64_tr_b16 v[182:183], v231 offset:41216
    v_mfma_f32_16x16x32_bf16 a[132:135], v[164:167], v[128:131], a[132:135]
    v_exp_f32 v250, v250
    v_mfma_f32_16x16x32_bf16 a[136:139], v[164:167], v[132:135], a[136:139]
    v_exp_f32 v251, v251
    v_mfma_f32_16x16x32_bf16 a[140:143], v[164:167], v[136:139], a[140:143]
    v_add_f32 v243, v243, v248
    ds_read_b64_tr_b16 v[152:153], v224 offset:49152
    ds_read_b64_tr_b16 v[154:155], v224 offset:57344
    s_waitcnt lgkmcnt(6)
    v_mfma_f32_16x16x32_bf16 a[144:147], v[168:171], v[128:131], a[144:147]
    v_add_f32 v243, v243, v249
    v_mfma_f32_16x16x32_bf16 a[148:151], v[168:171], v[132:135], a[148:151]
    v_cvt_pk_bf16_f32 v109, v248, v249
    v_mfma_f32_16x16x32_bf16 a[152:155], v[168:171], v[136:139], a[152:155]
    ds_read_b64_tr_b16 v[156:157], v225 offset:49152
    ds_read_b64_tr_b16 v[158:159], v225 offset:57344
    v_mfma_f32_16x16x32_bf16 a[156:159], v[172:175], v[128:131], a[156:159]
    v_fma_f32 v248, v20, s24, v236
    v_mfma_f32_16x16x32_bf16 a[160:163], v[172:175], v[132:135], a[160:163]
    v_fma_f32 v249, v21, s24, v236
    v_mfma_f32_16x16x32_bf16 a[164:167], v[172:175], v[136:139], a[164:167]
    v_exp_f32 v252, v252
    ds_read_b64_tr_b16 v[160:161], v226 offset:49152
    ds_read_b64_tr_b16 v[162:163], v226 offset:57344
    s_waitcnt lgkmcnt(6)
    v_mfma_f32_16x16x32_bf16 a[168:171], v[176:179], v[128:131], a[168:171]
    v_exp_f32 v253, v253
    v_mfma_f32_16x16x32_bf16 a[172:175], v[176:179], v[132:135], a[172:175]
    v_add_f32 v244, v250, v251
    v_mfma_f32_16x16x32_bf16 a[176:179], v[176:179], v[136:139], a[176:179]
    ds_read_b64_tr_b16 v[164:165], v227 offset:49152
    ds_read_b64_tr_b16 v[166:167], v227 offset:57344
    v_mfma_f32_16x16x32_bf16 a[180:183], v[180:183], v[128:131], a[180:183]
    v_cvt_pk_bf16_f32 v112, v250, v251
    v_mfma_f32_16x16x32_bf16 a[184:187], v[180:183], v[132:135], a[184:187]
    v_fma_f32 v250, v22, s24, v236
    v_mfma_f32_16x16x32_bf16 a[188:191], v[180:183], v[136:139], a[188:191]
    v_fma_f32 v251, v23, s24, v236
    ds_read_b64_tr_b16 v[168:169], v228 offset:49152
    ds_read_b64_tr_b16 v[170:171], v228 offset:57344
    s_waitcnt lgkmcnt(6)
    v_mfma_f32_16x16x32_bf16 a[0:3], v[152:155], v[140:143], a[0:3]
    v_exp_f32 v248, v248
    v_mfma_f32_16x16x32_bf16 a[4:7], v[152:155], v[144:147], a[4:7]
    v_exp_f32 v249, v249
    v_mfma_f32_16x16x32_bf16 a[8:11], v[152:155], v[148:151], a[8:11]
    v_add_f32 v244, v244, v252
    ds_read_b64_tr_b16 v[172:173], v229 offset:49152
    ds_read_b64_tr_b16 v[174:175], v229 offset:57344
    v_mfma_f32_16x16x32_bf16 a[12:15], v[156:159], v[140:143], a[12:15]
    v_mfma_f32_16x16x32_bf16 a[16:19], v[156:159], v[144:147], a[16:19]
    v_add_f32 v244, v244, v253
    v_mfma_f32_16x16x32_bf16 a[20:23], v[156:159], v[148:151], a[20:23]
    v_cvt_pk_bf16_f32 v113, v252, v253
    ds_read_b64_tr_b16 v[176:177], v230 offset:49152
    ds_read_b64_tr_b16 v[178:179], v230 offset:57344
    s_waitcnt lgkmcnt(6)
    v_mfma_f32_16x16x32_bf16 a[24:27], v[160:163], v[140:143], a[24:27]
    v_fma_f32 v252, v24, s24, v237
    v_mfma_f32_16x16x32_bf16 a[28:31], v[160:163], v[144:147], a[28:31]
    v_fma_f32 v253, v25, s24, v237
    v_mfma_f32_16x16x32_bf16 a[32:35], v[160:163], v[148:151], a[32:35]
    v_exp_f32 v250, v250
    ds_read_b64_tr_b16 v[180:181], v231 offset:49152
    ds_read_b64_tr_b16 v[182:183], v231 offset:57344
    v_mfma_f32_16x16x32_bf16 a[36:39], v[164:167], v[140:143], a[36:39]
    v_mfma_f32_16x16x32_bf16 a[40:43], v[164:167], v[144:147], a[40:43]
    v_exp_f32 v251, v251
    v_mfma_f32_16x16x32_bf16 a[44:47], v[164:167], v[148:151], a[44:47]
    v_add_f32 v242, v242, v248
    ds_read_b64_tr_b16 v[152:153], v224 offset:49408
    ds_read_b64_tr_b16 v[154:155], v224 offset:57600
    s_waitcnt lgkmcnt(6)
    v_mfma_f32_16x16x32_bf16 a[48:51], v[168:171], v[140:143], a[48:51]
    v_add_f32 v242, v242, v249
    v_mfma_f32_16x16x32_bf16 a[52:55], v[168:171], v[144:147], a[52:55]
    v_cvt_pk_bf16_f32 v106, v248, v249
    v_mfma_f32_16x16x32_bf16 a[56:59], v[168:171], v[148:151], a[56:59]
    v_fma_f32 v248, v26, s24, v237
    ds_read_b64_tr_b16 v[156:157], v225 offset:49408
    ds_read_b64_tr_b16 v[158:159], v225 offset:57600
    v_mfma_f32_16x16x32_bf16 a[60:63], v[172:175], v[140:143], a[60:63]
    v_fma_f32 v249, v27, s24, v237
    v_mfma_f32_16x16x32_bf16 a[64:67], v[172:175], v[144:147], a[64:67]
    v_mfma_f32_16x16x32_bf16 a[68:71], v[172:175], v[148:151], a[68:71]
    v_exp_f32 v252, v252
    ds_read_b64_tr_b16 v[160:161], v226 offset:49408
    ds_read_b64_tr_b16 v[162:163], v226 offset:57600
    s_waitcnt lgkmcnt(6)
    v_mfma_f32_16x16x32_bf16 a[72:75], v[176:179], v[140:143], a[72:75]
    v_exp_f32 v253, v253
    v_mfma_f32_16x16x32_bf16 a[76:79], v[176:179], v[144:147], a[76:79]
    v_add_f32 v242, v242, v250
    v_mfma_f32_16x16x32_bf16 a[80:83], v[176:179], v[148:151], a[80:83]
    v_add_f32 v242, v242, v251
    ds_read_b64_tr_b16 v[164:165], v227 offset:49408
    ds_read_b64_tr_b16 v[166:167], v227 offset:57600
    v_mfma_f32_16x16x32_bf16 a[84:87], v[180:183], v[140:143], a[84:87]
    v_cvt_pk_bf16_f32 v107, v250, v251
    v_mfma_f32_16x16x32_bf16 a[88:91], v[180:183], v[144:147], a[88:91]
    v_mfma_f32_16x16x32_bf16 a[92:95], v[180:183], v[148:151], a[92:95]
    v_fma_f32 v250, v28, s24, v238
    ds_read_b64_tr_b16 v[168:169], v228 offset:49408
    ds_read_b64_tr_b16 v[170:171], v228 offset:57600
    s_waitcnt lgkmcnt(6)
    v_mfma_f32_16x16x32_bf16 a[96:99], v[152:155], v[140:143], a[96:99]
    v_fma_f32 v251, v29, s24, v238
    v_mfma_f32_16x16x32_bf16 a[100:103], v[152:155], v[144:147], a[100:103]
    v_exp_f32 v248, v248
    v_mfma_f32_16x16x32_bf16 a[104:107], v[152:155], v[148:151], a[104:107]
    v_exp_f32 v249, v249
    ds_read_b64_tr_b16 v[172:173], v229 offset:49408
    ds_read_b64_tr_b16 v[174:175], v229 offset:57600
    v_mfma_f32_16x16x32_bf16 a[108:111], v[156:159], v[140:143], a[108:111]
    v_add_f32 v243, v243, v252
    v_mfma_f32_16x16x32_bf16 a[112:115], v[156:159], v[144:147], a[112:115]
    v_mfma_f32_16x16x32_bf16 a[116:119], v[156:159], v[148:151], a[116:119]
    v_add_f32 v243, v243, v253
    ds_read_b64_tr_b16 v[176:177], v230 offset:49408
    ds_read_b64_tr_b16 v[178:179], v230 offset:57600
    s_waitcnt lgkmcnt(6)
    v_mfma_f32_16x16x32_bf16 a[120:123], v[160:163], v[140:143], a[120:123]
    v_cvt_pk_bf16_f32 v110, v252, v253
    v_mfma_f32_16x16x32_bf16 a[124:127], v[160:163], v[144:147], a[124:127]
    v_fma_f32 v252, v30, s24, v238
    v_mfma_f32_16x16x32_bf16 a[128:131], v[160:163], v[148:151], a[128:131]
    v_fma_f32 v253, v31, s24, v238
    ds_read_b64_tr_b16 v[180:181], v231 offset:49408
    ds_read_b64_tr_b16 v[182:183], v231 offset:57600
    v_mfma_f32_16x16x32_bf16 a[132:135], v[164:167], v[140:143], a[132:135]
    v_exp_f32 v250, v250
    v_mfma_f32_16x16x32_bf16 a[136:139], v[164:167], v[144:147], a[136:139]
    v_exp_f32 v251, v251
    v_mfma_f32_16x16x32_bf16 a[140:143], v[164:167], v[148:151], a[140:143]
    s_waitcnt lgkmcnt(4)
    v_mfma_f32_16x16x32_bf16 a[144:147], v[168:171], v[140:143], a[144:147]
    v_add_f32 v243, v243, v248
    v_mfma_f32_16x16x32_bf16 a[148:151], v[168:171], v[144:147], a[148:151]
    v_add_f32 v243, v243, v249
    v_mfma_f32_16x16x32_bf16 a[152:155], v[168:171], v[148:151], a[152:155]
    v_cvt_pk_bf16_f32 v111, v248, v249
    v_mfma_f32_16x16x32_bf16 a[156:159], v[172:175], v[140:143], a[156:159]
    v_exp_f32 v252, v252
    v_mfma_f32_16x16x32_bf16 a[160:163], v[172:175], v[144:147], a[160:163]
    v_exp_f32 v253, v253
    v_mfma_f32_16x16x32_bf16 a[164:167], v[172:175], v[148:151], a[164:167]
    s_waitcnt lgkmcnt(0)
    v_mfma_f32_16x16x32_bf16 a[168:171], v[176:179], v[140:143], a[168:171]
    v_add_f32 v244, v244, v250
    v_mfma_f32_16x16x32_bf16 a[172:175], v[176:179], v[144:147], a[172:175]
    v_add_f32 v244, v244, v251
    v_mfma_f32_16x16x32_bf16 a[176:179], v[176:179], v[148:151], a[176:179]
    v_cvt_pk_bf16_f32 v114, v250, v251
    v_mfma_f32_16x16x32_bf16 a[180:183], v[180:183], v[140:143], a[180:183]
    v_add_f32 v244, v244, v252
    v_mfma_f32_16x16x32_bf16 a[184:187], v[180:183], v[144:147], a[184:187]
    v_add_f32 v244, v244, v253
    v_mfma_f32_16x16x32_bf16 a[188:191], v[180:183], v[148:151], a[188:191]
    v_cvt_pk_bf16_f32 v115, v252, v253
    s_waitcnt vmcnt(0)
    s_barrier
    s_add_u32 s26, s26, 1
    s_cmp_lt_u32 s26, 7
    s_cbranch_scc1 L_loop
    ds_read_b128 v[152:155], v216 offset:32768
    ds_read_b128 v[156:159], v217 offset:32768
    ds_read_b128 v[160:163], v218 offset:32768
    ds_read_b128 v[164:167], v219 offset:32768
    ds_read_b128 v[168:171], v220 offset:32768
    s_waitcnt lgkmcnt(3)
    v_mfma_f32_16x16x32_bf16 v[56:59], v[152:155], a[192:195], 0
    s_add_u32 m0, s27, 98304
    v_mfma_f32_16x16x32_bf16 v[60:63], v[152:155], a[224:227], 0
    s_nop 0
    v_mfma_f32_16x16x32_bf16 v[64:67], v[152:155], v[184:187], 0
    buffer_load_dwordx4 v232, s[16:19], s30 offen offset:0 lds
    ds_read_b128 v[172:175], v221 offset:32768
    v_mfma_f32_16x16x32_bf16 v[56:59], v[156:159], a[196:199], v[56:59]
    v_fma_f32 v248, v32, s24, v236
    v_mfma_f32_16x16x32_bf16 v[60:63], v[156:159], a[228:231], v[60:63]
    v_fma_f32 v249, v33, s24, v236
    v_mfma_f32_16x16x32_bf16 v[64:67], v[156:159], v[188:191], v[64:67]
    v_fma_f32 v250, v34, s24, v236
    ds_read_b128 v[176:179], v222 offset:32768
    s_waitcnt lgkmcnt(3)
    v_mfma_f32_16x16x32_bf16 v[56:59], v[160:163], a[200:203], v[56:59]
    v_fma_f32 v251, v35, s24, v236
    v_mfma_f32_16x16x32_bf16 v[60:63], v[160:163], a[232:235], v[60:63]
    buffer_load_dwordx4 v233, s[16:19], s30 offen offset:1024 lds
    v_mfma_f32_16x16x32_bf16 v[64:67], v[160:163], v[192:195], v[64:67]
    v_exp_f32 v248, v248
    ds_read_b128 v[180:183], v223 offset:32768
    v_mfma_f32_16x16x32_bf16 v[56:59], v[164:167], a[204:207], v[56:59]
    v_exp_f32 v249, v249
    v_mfma_f32_16x16x32_bf16 v[60:63], v[164:167], a[236:239], v[60:63]
    v_fma_f32 v252, v36, s24, v237
    v_mfma_f32_16x16x32_bf16 v[64:67], v[164:167], v[196:199], v[64:67]
    v_fma_f32 v253, v37, s24, v237
    ds_read_b128 v[152:155], v216 offset:40960
    s_waitcnt lgkmcnt(3)
    v_mfma_f32_16x16x32_bf16 v[56:59], v[168:171], a[208:211], v[56:59]
    buffer_load_dwordx4 v234, s[16:19], s30 offen offset:2048 lds
    v_exp_f32 v250, v250
    v_mfma_f32_16x16x32_bf16 v[60:63], v[168:171], a[240:243], v[60:63]
    v_exp_f32 v251, v251
    v_mfma_f32_16x16x32_bf16 v[64:67], v[168:171], v[200:203], v[64:67]
    v_add_f32 v245, v248, v249
    ds_read_b128 v[156:159], v217 offset:40960
    v_mfma_f32_16x16x32_bf16 v[56:59], v[172:175], a[212:215], v[56:59]
    v_cvt_pk_bf16_f32 v116, v248, v249
    v_mfma_f32_16x16x32_bf16 v[60:63], v[172:175], a[244:247], v[60:63]
    buffer_load_dwordx4 v235, s[16:19], s30 offen offset:3072 lds
    v_mfma_f32_16x16x32_bf16 v[64:67], v[172:175], v[204:207], v[64:67]
    v_fma_f32 v248, v38, s24, v237
    ds_read_b128 v[160:163], v218 offset:40960
    s_waitcnt lgkmcnt(3)
    v_mfma_f32_16x16x32_bf16 v[56:59], v[176:179], a[216:219], v[56:59]
    v_fma_f32 v249, v39, s24, v237
    v_mfma_f32_16x16x32_bf16 v[60:63], v[176:179], a[248:251], v[60:63]
    v_exp_f32 v252, v252
    v_mfma_f32_16x16x32_bf16 v[64:67], v[176:179], v[208:211], v[64:67]
    v_exp_f32 v253, v253
    ds_read_b128 v[164:167], v219 offset:40960
    v_mfma_f32_16x16x32_bf16 v[56:59], v[180:183], a[220:223], v[56:59]
    s_add_u32 m0, s27, 102400
    v_mfma_f32_16x16x32_bf16 v[60:63], v[180:183], a[252:255], v[60:63]
    s_nop 0
    v_mfma_f32_16x16x32_bf16 v[64:67], v[180:183], v[212:215], v[64:67]
    buffer_load_dwordx4 v232, s[16:19], s31 offen offset:0 lds
    ds_read_b128 v[168:171], v220 offset:40960
    s_waitcnt lgkmcnt(3)
    v_mfma_f32_16x16x32_bf16 v[68:71], v[152:155], a[192:195], 0
    v_add_f32 v245, v245, v250
    v_add_f32 v245, v245, v251
    v_mfma_f32_16x16x32_bf16 v[72:75], v[152:155], a[224:227], 0
    v_cvt_pk_bf16_f32 v117, v250, v251
    v_mfma_f32_16x16x32_bf16 v[76:79], v[152:155], v[184:187], 0
    v_fma_f32 v250, v40, s24, v238
    ds_read_b128 v[172:175], v221 offset:40960
    v_mfma_f32_16x16x32_bf16 v[68:71], v[156:159], a[196:199], v[68:71]
    buffer_load_dwordx4 v233, s[16:19], s31 offen offset:1024 lds
    v_mfma_f32_16x16x32_bf16 v[72:75], v[156:159], a[228:231], v[72:75]
    v_fma_f32 v251, v41, s24, v238
    v_mfma_f32_16x16x32_bf16 v[76:79], v[156:159], v[188:191], v[76:79]
    v_exp_f32 v248, v248
    ds_read_b128 v[176:179], v222 offset:40960
    s_waitcnt lgkmcnt(3)
    v_mfma_f32_16x16x32_bf16 v[68:71], v[160:163], a[200:203], v[68:71]
    v_exp_f32 v249, v249
    v_mfma_f32_16x16x32_bf16 v[72:75], v[160:163], a[232:235], v[72:75]
    v_add_f32 v246, v252, v253
    v_mfma_f32_16x16x32_bf16 v[76:79], v[160:163], v[192:195], v[76:79]
    buffer_load_dwordx4 v234, s[16:19], s31 offen offset:2048 lds
    ds_read_b128 v[180:183], v223 offset:40960
    v_mfma_f32_16x16x32_bf16 v[68:71], v[164:167], a[204:207], v[68:71]
    v_cvt_pk_bf16_f32 v120, v252, v253
    v_mfma_f32_16x16x32_bf16 v[72:75], v[164:167], a[236:239], v[72:75]
    v_fma_f32 v252, v42, s24, v238
    v_mfma_f32_16x16x32_bf16 v[76:79], v[164:167], v[196:199], v[76:79]
    v_fma_f32 v253, v43, s24, v238
    ds_read_b128 v[152:155], v216 offset:49152
    s_waitcnt lgkmcnt(3)
    v_mfma_f32_16x16x32_bf16 v[68:71], v[168:171], a[208:211], v[68:71]
    v_exp_f32 v250, v250
    buffer_load_dwordx4 v235, s[16:19], s31 offen offset:3072 lds
    v_mfma_f32_16x16x32_bf16 v[72:75], v[168:171], a[240:243], v[72:75]
    v_exp_f32 v251, v251
    v_mfma_f32_16x16x32_bf16 v[76:79], v[168:171], v[200:203], v[76:79]
    v_add_f32 v246, v246, v248
    ds_read_b128 v[156:159], v217 offset:49152
    v_mfma_f32_16x16x32_bf16 v[68:71], v[172:175], a[212:215], v[68:71]
    v_add_f32 v246, v246, v249
    v_mfma_f32_16x16x32_bf16 v[72:75], v[172:175], a[244:247], v[72:75]
    v_cvt_pk_bf16_f32 v121, v248, v249
    v_mfma_f32_16x16x32_bf16 v[76:79], v[172:175], v[204:207], v[76:79]
    v_fma_f32 v248, v44, s24, v236
    ds_read_b128 v[160:163], v218 offset:49152
    s_waitcnt lgkmcnt(3)
    v_mfma_f32_16x16x32_bf16 v[68:71], v[176:179], a[216:219], v[68:71]
    v_fma_f32 v249, v45, s24, v236
    v_mfma_f32_16x16x32_bf16 v[72:75], v[176:179], a[248:251], v[72:75]
    v_exp_f32 v252, v252
    v_mfma_f32_16x16x32_bf16 v[76:79], v[176:179], v[208:211], v[76:79]
    v_exp_f32 v253, v253
    ds_read_b128 v[164:167], v219 offset:49152
    v_mfma_f32_16x16x32_bf16 v[68:71], v[180:183], a[220:223], v[68:71]
    v_add_f32 v247, v250, v251
    v_mfma_f32_16x16x32_bf16 v[72:75], v[180:183], a[252:255], v[72:75]
    v_cvt_pk_bf16_f32 v124, v250, v251
    v_mfma_f32_16x16x32_bf16 v[76:79], v[180:183], v[212:215], v[76:79]
    v_fma_f32 v250, v46, s24, v236
    ds_read_b128 v[168:171], v220 offset:49152
    s_waitcnt lgkmcnt(3)
    v_mfma_f32_16x16x32_bf16 v[80:83], v[152:155], a[192:195], 0
    v_fma_f32 v251, v47, s24, v236
    v_exp_f32 v248, v248
    v_mfma_f32_16x16x32_bf16 v[84:87], v[152:155], a[224:227], 0
    v_exp_f32 v249, v249
    v_mfma_f32_16x16x32_bf16 v[88:91], v[152:155], v[184:187], 0
    v_add_f32 v247, v247, v252
    ds_read_b128 v[172:175], v221 offset:49152
    v_mfma_f32_16x16x32_bf16 v[80:83], v[156:159], a[196:199], v[80:83]
    v_add_f32 v247, v247, v253
    v_mfma_f32_16x16x32_bf16 v[84:87], v[156:159], a[228:231], v[84:87]
    v_cvt_pk_bf16_f32 v125, v252, v253
    v_mfma_f32_16x16x32_bf16 v[88:91], v[156:159], v[188:191], v[88:91]
    v_fma_f32 v252, v48, s24, v237
    ds_read_b128 v[176:179], v222 offset:49152
    s_waitcnt lgkmcnt(3)
    v_mfma_f32_16x16x32_bf16 v[80:83], v[160:163], a[200:203], v[80:83]
    v_fma_f32 v253, v49, s24, v237
    v_mfma_f32_16x16x32_bf16 v[84:87], v[160:163], a[232:235], v[84:87]
    v_exp_f32 v250, v250
    v_mfma_f32_16x16x32_bf16 v[88:91], v[160:163], v[192:195], v[88:91]
    v_exp_f32 v251, v251
    ds_read_b128 v[180:183], v223 offset:49152
    v_mfma_f32_16x16x32_bf16 v[80:83], v[164:167], a[204:207], v[80:83]
    v_add_f32 v245, v245, v248
    v_mfma_f32_16x16x32_bf16 v[84:87], v[164:167], a[236:239], v[84:87]
    v_add_f32 v245, v245, v249
    v_mfma_f32_16x16x32_bf16 v[88:91], v[164:167], v[196:199], v[88:91]
    v_cvt_pk_bf16_f32 v118, v248, v249
    ds_read_b128 v[152:155], v216 offset:57344
    s_waitcnt lgkmcnt(3)
    v_mfma_f32_16x16x32_bf16 v[80:83], v[168:171], a[208:211], v[80:83]
    v_fma_f32 v248, v50, s24, v237
    v_fma_f32 v249, v51, s24, v237
    v_mfma_f32_16x16x32_bf16 v[84:87], v[168:171], a[240:243], v[84:87]
    v_exp_f32 v252, v252
    v_mfma_f32_16x16x32_bf16 v[88:91], v[168:171], v[200:203], v[88:91]
    v_exp_f32 v253, v253
    ds_read_b128 v[156:159], v217 offset:57344
    v_mfma_f32_16x16x32_bf16 v[80:83], v[172:175], a[212:215], v[80:83]
    v_add_f32 v245, v245, v250
    v_mfma_f32_16x16x32_bf16 v[84:87], v[172:175], a[244:247], v[84:87]
    v_add_f32 v245, v245, v251
    v_mfma_f32_16x16x32_bf16 v[88:91], v[172:175], v[204:207], v[88:91]
    v_cvt_pk_bf16_f32 v119, v250, v251
    ds_read_b128 v[160:163], v218 offset:57344
    s_waitcnt lgkmcnt(3)
    v_mfma_f32_16x16x32_bf16 v[80:83], v[176:179], a[216:219], v[80:83]
    v_fma_f32 v250, v52, s24, v238
    v_mfma_f32_16x16x32_bf16 v[84:87], v[176:179], a[248:251], v[84:87]
    v_fma_f32 v251, v53, s24, v238
    v_mfma_f32_16x16x32_bf16 v[88:91], v[176:179], v[208:211], v[88:91]
    v_exp_f32 v248, v248
    ds_read_b128 v[164:167], v219 offset:57344
    v_mfma_f32_16x16x32_bf16 v[80:83], v[180:183], a[220:223], v[80:83]
    v_exp_f32 v249, v249
    v_mfma_f32_16x16x32_bf16 v[84:87], v[180:183], a[252:255], v[84:87]
    v_add_f32 v246, v246, v252
    v_mfma_f32_16x16x32_bf16 v[88:91], v[180:183], v[212:215], v[88:91]
    v_add_f32 v246, v246, v253
    ds_read_b128 v[168:171], v220 offset:57344
    s_waitcnt lgkmcnt(3)
    v_mfma_f32_16x16x32_bf16 v[92:95], v[152:155], a[192:195], 0
    v_cvt_pk_bf16_f32 v122, v252, v253
    v_fma_f32 v252, v54, s24, v238
    v_mfma_f32_16x16x32_bf16 v[96:99], v[152:155], a[224:227], 0
    v_fma_f32 v253, v55, s24, v238
    v_mfma_f32_16x16x32_bf16 v[100:103], v[152:155], v[184:187], 0
    v_exp_f32 v250, v250
    ds_read_b128 v[172:175], v221 offset:57344
    v_mfma_f32_16x16x32_bf16 v[92:95], v[156:159], a[196:199], v[92:95]
    v_exp_f32 v251, v251
    v_mfma_f32_16x16x32_bf16 v[96:99], v[156:159], a[228:231], v[96:99]
    v_add_f32 v246, v246, v248
    v_mfma_f32_16x16x32_bf16 v[100:103], v[156:159], v[188:191], v[100:103]
    v_add_f32 v246, v246, v249
    ds_read_b128 v[176:179], v222 offset:57344
    s_waitcnt lgkmcnt(3)
    v_mfma_f32_16x16x32_bf16 v[92:95], v[160:163], a[200:203], v[92:95]
    v_cvt_pk_bf16_f32 v123, v248, v249
    v_mfma_f32_16x16x32_bf16 v[96:99], v[160:163], a[232:235], v[96:99]
    v_exp_f32 v252, v252
    v_mfma_f32_16x16x32_bf16 v[100:103], v[160:163], v[192:195], v[100:103]
    v_exp_f32 v253, v253
    ds_read_b128 v[180:183], v223 offset:57344
    v_mfma_f32_16x16x32_bf16 v[92:95], v[164:167], a[204:207], v[92:95]
    v_add_f32 v247, v247, v250
    v_mfma_f32_16x16x32_bf16 v[96:99], v[164:167], a[236:239], v[96:99]
    v_add_f32 v247, v247, v251
    v_mfma_f32_16x16x32_bf16 v[100:103], v[164:167], v[196:199], v[100:103]
    v_cvt_pk_bf16_f32 v126, v250, v251
    ds_read_b64_tr_b16 v[152:153], v224 offset:0
    ds_read_b64_tr_b16 v[154:155], v224 offset:8192
    s_waitcnt lgkmcnt(4)
    v_mfma_f32_16x16x32_bf16 v[92:95], v[168:171], a[208:211], v[92:95]
    v_add_f32 v247, v247, v252
    v_add_f32 v247, v247, v253
    v_mfma_f32_16x16x32_bf16 v[96:99], v[168:171], a[240:243], v[96:99]
    v_cvt_pk_bf16_f32 v127, v252, v253
    v_mfma_f32_16x16x32_bf16 v[100:103], v[168:171], v[200:203], v[100:103]
    s_add_u32 s30, s30, 32768
    ds_read_b64_tr_b16 v[156:157], v225 offset:0
    ds_read_b64_tr_b16 v[158:159], v225 offset:8192
    v_mfma_f32_16x16x32_bf16 v[92:95], v[172:175], a[212:215], v[92:95]
    s_add_u32 s31, s31, 32768
    v_mfma_f32_16x16x32_bf16 v[96:99], v[172:175], a[244:247], v[96:99]
    v_add_f32 v254, v242, v245
    v_mfma_f32_16x16x32_bf16 v[100:103], v[172:175], v[204:207], v[100:103]
    v_add_f32 v255, v243, v246
    ds_read_b64_tr_b16 v[160:161], v226 offset:0
    ds_read_b64_tr_b16 v[162:163], v226 offset:8192
    s_waitcnt lgkmcnt(6)
    v_mfma_f32_16x16x32_bf16 v[92:95], v[176:179], a[216:219], v[92:95]
    v_add_f32 v1, v244, v247
    v_mfma_f32_16x16x32_bf16 v[96:99], v[176:179], a[248:251], v[96:99]
    v_max3_f32 v5, v254, v255, v1
    v_mfma_f32_16x16x32_bf16 v[100:103], v[176:179], v[208:211], v[100:103]
    v_cmp_nge_f32 vcc, s25, v5
    ds_read_b64_tr_b16 v[164:165], v227 offset:0
    ds_read_b64_tr_b16 v[166:167], v227 offset:8192
    v_mfma_f32_16x16x32_bf16 v[92:95], v[180:183], a[220:223], v[92:95]
    s_nop 4
    s_cbranch_vccnz L_slow_t0
L_back_t0:
    v_mfma_f32_16x16x32_bf16 v[96:99], v[180:183], a[252:255], v[96:99]
    v_add_f32 v239, v239, v254
    v_mfma_f32_16x16x32_bf16 v[100:103], v[180:183], v[212:215], v[100:103]
    v_add_f32 v240, v240, v255
    v_add_f32 v241, v241, v1
    ds_read_b64_tr_b16 v[168:169], v228 offset:0
    ds_read_b64_tr_b16 v[170:171], v228 offset:8192
    s_waitcnt lgkmcnt(6)
    v_mfma_f32_16x16x32_bf16 a[0:3], v[152:155], v[104:107], a[0:3]
    v_mfma_f32_16x16x32_bf16 a[4:7], v[152:155], v[108:111], a[4:7]
    v_fma_f32 v248, v56, s24, v236
    v_mfma_f32_16x16x32_bf16 a[8:11], v[152:155], v[112:115], a[8:11]
    v_fma_f32 v249, v57, s24, v236
    ds_read_b64_tr_b16 v[172:173], v229 offset:0
    ds_read_b64_tr_b16 v[174:175], v229 offset:8192
    v_mfma_f32_16x16x32_bf16 a[12:15], v[156:159], v[104:107], a[12:15]
    v_fma_f32 v250, v58, s24, v236
    v_mfma_f32_16x16x32_bf16 a[16:19], v[156:159], v[108:111], a[16:19]
    v_fma_f32 v251, v59, s24, v236
    v_mfma_f32_16x16x32_bf16 a[20:23], v[156:159], v[112:115], a[20:23]
    v_exp_f32 v248, v248
    ds_read_b64_tr_b16 v[176:177], v230 offset:0
    ds_read_b64_tr_b16 v[178:179], v230 offset:8192
    s_waitcnt lgkmcnt(6)
    v_mfma_f32_16x16x32_bf16 a[24:27], v[160:163], v[104:107], a[24:27]
    v_mfma_f32_16x16x32_bf16 a[28:31], v[160:163], v[108:111], a[28:31]
    v_exp_f32 v249, v249
    v_mfma_f32_16x16x32_bf16 a[32:35], v[160:163], v[112:115], a[32:35]
    v_fma_f32 v252, v60, s24, v237
    ds_read_b64_tr_b16 v[180:181], v231 offset:0
    ds_read_b64_tr_b16 v[182:183], v231 offset:8192
    v_mfma_f32_16x16x32_bf16 a[36:39], v[164:167], v[104:107], a[36:39]
    v_fma_f32 v253, v61, s24, v237
    v_mfma_f32_16x16x32_bf16 a[40:43], v[164:167], v[108:111], a[40:43]
    v_exp_f32 v250, v250
    v_mfma_f32_16x16x32_bf16 a[44:47], v[164:167], v[112:115], a[44:47]
    v_exp_f32 v251, v251
    ds_read_b64_tr_b16 v[152:153], v224 offset:256
    ds_read_b64_tr_b16 v[154:155], v224 offset:8448
    s_waitcnt lgkmcnt(6)
    v_mfma_f32_16x16x32_bf16 a[48:51], v[168:171], v[104:107], a[48:51]
    v_mfma_f32_16x16x32_bf16 a[52:55], v[168:171], v[108:111], a[52:55]
    v_add_f32 v242, v248, v249
    v_mfma_f32_16x16x32_bf16 a[56:59], v[168:171], v[112:115], a[56:59]
    v_cvt_pk_bf16_f32 v128, v248, v249
    ds_read_b64_tr_b16 v[156:157], v225 offset:256
    ds_read_b64_tr_b16 v[158:159], v225 offset:8448
    v_mfma_f32_16x16x32_bf16 a[60:63], v[172:175], v[104:107], a[60:63]
    v_fma_f32 v248, v62, s24, v237
    v_mfma_f32_16x16x32_bf16 a[64:67], v[172:175], v[108:111], a[64:67]
    v_fma_f32 v249, v63, s24, v237
    v_mfma_f32_16x16x32_bf16 a[68:71], v[172:175], v[112:115], a[68:71]
    v_exp_f32 v252, v252
    ds_read_b64_tr_b16 v[160:161], v226 offset:256
    ds_read_b64_tr_b16 v[162:163], v226 offset:8448
    s_waitcnt lgkmcnt(6)
    v_mfma_f32_16x16x32_bf16 a[72:75], v[176:179], v[104:107], a[72:75]
    v_exp_f32 v253, v253
    v_mfma_f32_16x16x32_bf16 a[76:79], v[176:179], v[108:111], a[76:79]
    v_mfma_f32_16x16x32_bf16 a[80:83], v[176:179], v[112:115], a[80:83]
    v_add_f32 v242, v242, v250
    ds_read_b64_tr_b16 v[164:165], v227 offset:256
    ds_read_b64_tr_b16 v[166:167], v227 offset:8448
    v_mfma_f32_16x16x32_bf16 a[84:87], v[180:183], v[104:107], a[84:87]
    v_add_f32 v242, v242, v251
    v_mfma_f32_16x16x32_bf16 a[88:91], v[180:183], v[108:111], a[88:91]
    v_cvt_pk_bf16_f32 v129, v250, v251
    v_mfma_f32_16x16x32_bf16 a[92:95], v[180:183], v[112:115], a[92:95]
    v_fma_f32 v250, v64, s24, v238
    ds_read_b64_tr_b16 v[168:169], v228 offset:256
    ds_read_b64_tr_b16 v[170:171], v228 offset:8448
    s_waitcnt lgkmcnt(6)
    v_mfma_f32_16x16x32_bf16 a[96:99], v[152:155], v[104:107], a[96:99]
    v_fma_f32 v251, v65, s24, v238
    v_mfma_f32_16x16x32_bf16 a[100:103], v[152:155], v[108:111], a[100:103]
    v_mfma_f32_16x16x32_bf16 a[104:107], v[152:155], v[112:115], a[104:107]
    v_exp_f32 v248, v248
    ds_read_b64_tr_b16 v[172:173], v229 offset:256
    ds_read_b64_tr_b16 v[174:175], v229 offset:8448
    v_mfma_f32_16x16x32_bf16 a[108:111], v[156:159], v[104:107], a[108:111]
    v_exp_f32 v249, v249
    v_mfma_f32_16x16x32_bf16 a[112:115], v[156:159], v[108:111], a[112:115]
    v_add_f32 v243, v252, v253
    v_mfma_f32_16x16x32_bf16 a[116:119], v[156:159], v[112:115], a[116:119]
    v_cvt_pk_bf16_f32 v132, v252, v253
    ds_read_b64_tr_b16 v[176:177], v230 offset:256
    ds_read_b64_tr_b16 v[178:179], v230 offset:8448
    s_waitcnt lgkmcnt(6)
    v_mfma_f32_16x16x32_bf16 a[120:123], v[160:163], v[104:107], a[120:123]
    v_fma_f32 v252, v66, s24, v238
    v_mfma_f32_16x16x32_bf16 a[124:127], v[160:163], v[108:111], a[124:127]
    v_fma_f32 v253, v67, s24, v238
    v_mfma_f32_16x16x32_bf16 a[128:131], v[160:163], v[112:115], a[128:131]
    ds_read_b64_tr_b16 v[180:181], v231 offset:256
    ds_read_b64_tr_b16 v[182:183], v231 offset:8448
    v_mfma_f32_16x16x32_bf16 a[132:135], v[164:167], v[104:107], a[132:135]
    v_exp_f32 v250, v250
    v_mfma_f32_16x16x32_bf16 a[136:139], v[164:167], v[108:111], a[136:139]
    v_exp_f32 v251, v251
    v_mfma_f32_16x16x32_bf16 a[140:143], v[164:167], v[112:115], a[140:143]
    v_add_f32 v243, v243, v248
    ds_read_b64_tr_b16 v[152:153], v224 offset:16384
    ds_read_b64_tr_b16 v[154:155], v224 offset:24576
    s_waitcnt lgkmcnt(6)
    v_mfma_f32_16x16x32_bf16 a[144:147], v[168:171], v[104:107], a[144:147]
    v_add_f32 v243, v243, v249
    v_mfma_f32_16x16x32_bf16 a[148:151], v[168:171], v[108:111], a[148:151]
    v_cvt_pk_bf16_f32 v133, v248, v249
    v_mfma_f32_16x16x32_bf16 a[152:155], v[168:171], v[112:115], a[152:155]
    ds_read_b64_tr_b16 v[156:157], v225 offset:16384
    ds_read_b64_tr_b16 v[158:159], v225 offset:24576
    v_mfma_f32_16x16x32_bf16 a[156:159], v[172:175], v[104:107], a[156:159]
    v_fma_f32 v248, v68, s24, v236
    v_mfma_f32_16x16x32_bf16 a[160:163], v[172:175], v[108:111], a[160:163]
    v_fma_f32 v249, v69, s24, v236
    v_mfma_f32_16x16x32_bf16 a[164:167], v[172:175], v[112:115], a[164:167]
    v_exp_f32 v252, v252
    ds_read_b64_tr_b16 v[160:161], v226 offset:16384
    ds_read_b64_tr_b16 v[162:163], v226 offset:24576
    s_waitcnt lgkmcnt(6)
    v_mfma_f32_16x16x32_bf16 a[168:171], v[176:179], v[104:107], a[168:171]
    v_exp_f32 v253, v253
    v_mfma_f32_16x16x32_bf16 a[172:175], v[176:179], v[108:111], a[172:175]
    v_add_f32 v244, v250, v251
    v_mfma_f32_16x16x32_bf16 a[176:179], v[176:179], v[112:115], a[176:179]
    ds_read_b64_tr_b16 v[164:165], v227 offset:16384
    ds_read_b64_tr_b16 v[166:167], v227 offset:24576
    v_mfma_f32_16x16x32_bf16 a[180:183], v[180:183], v[104:107], a[180:183]
    v_cvt_pk_bf16_f32 v136, v250, v251
    v_mfma_f32_16x16x32_bf16 a[184:187], v[180:183], v[108:111], a[184:187]
    v_fma_f32 v250, v70, s24, v236
    v_mfma_f32_16x16x32_bf16 a[188:191], v[180:183], v[112:115], a[188:191]
    v_fma_f32 v251, v71, s24, v236
    ds_read_b64_tr_b16 v[168:169], v228 offset:16384
    ds_read_b64_tr_b16 v[170:171], v228 offset:24576
    s_waitcnt lgkmcnt(6)
    v_mfma_f32_16x16x32_bf16 a[0:3], v[152:155], v[116:119], a[0:3]
    v_exp_f32 v248, v248
    v_mfma_f32_16x16x32_bf16 a[4:7], v[152:155], v[120:123], a[4:7]
    v_exp_f32 v249, v249
    v_mfma_f32_16x16x32_bf16 a[8:11], v[152:155], v[124:127], a[8:11]
    v_add_f32 v244, v244, v252
    ds_read_b64_tr_b16 v[172:173], v229 offset:16384
    ds_read_b64_tr_b16 v[174:175], v229 offset:24576
    v_mfma_f32_16x16x32_bf16 a[12:15], v[156:159], v[116:119], a[12:15]
    v_mfma_f32_16x16x32_bf16 a[16:19], v[156:159], v[120:123], a[16:19]
    v_add_f32 v244, v244, v253
    v_mfma_f32_16x16x32_bf16 a[20:23], v[156:159], v[124:127], a[20:23]
    v_cvt_pk_bf16_f32 v137, v252, v253
    ds_read_b64_tr_b16 v[176:177], v230 offset:16384
    ds_read_b64_tr_b16 v[178:179], v230 offset:24576
    s_waitcnt lgkmcnt(6)
    v_mfma_f32_16x16x32_bf16 a[24:27], v[160:163], v[116:119], a[24:27]
    v_fma_f32 v252, v72, s24, v237
    v_mfma_f32_16x16x32_bf16 a[28:31], v[160:163], v[120:123], a[28:31]
    v_fma_f32 v253, v73, s24, v237
    v_mfma_f32_16x16x32_bf16 a[32:35], v[160:163], v[124:127], a[32:35]
    v_exp_f32 v250, v250
    ds_read_b64_tr_b16 v[180:181], v231 offset:16384
    ds_read_b64_tr_b16 v[182:183], v231 offset:24576
    v_mfma_f32_16x16x32_bf16 a[36:39], v[164:167], v[116:119], a[36:39]
    v_mfma_f32_16x16x32_bf16 a[40:43], v[164:167], v[120:123], a[40:43]
    v_exp_f32 v251, v251
    v_mfma_f32_16x16x32_bf16 a[44:47], v[164:167], v[124:127], a[44:47]
    v_add_f32 v242, v242, v248
    ds_read_b64_tr_b16 v[152:153], v224 offset:16640
    ds_read_b64_tr_b16 v[154:155], v224 offset:24832
    s_waitcnt lgkmcnt(6)
    v_mfma_f32_16x16x32_bf16 a[48:51], v[168:171], v[116:119], a[48:51]
    v_add_f32 v242, v242, v249
    v_mfma_f32_16x16x32_bf16 a[52:55], v[168:171], v[120:123], a[52:55]
    v_cvt_pk_bf16_f32 v130, v248, v249
    v_mfma_f32_16x16x32_bf16 a[56:59], v[168:171], v[124:127], a[56:59]
    v_fma_f32 v248, v74, s24, v237
    ds_read_b64_tr_b16 v[156:157], v225 offset:16640
    ds_read_b64_tr_b16 v[158:159], v225 offset:24832
    v_mfma_f32_16x16x32_bf16 a[60:63], v[172:175], v[116:119], a[60:63]
    v_fma_f32 v249, v75, s24, v237
    v_mfma_f32_16x16x32_bf16 a[64:67], v[172:175], v[120:123], a[64:67]
    v_mfma_f32_16x16x32_bf16 a[68:71], v[172:175], v[124:127], a[68:71]
    v_exp_f32 v252, v252
    ds_read_b64_tr_b16 v[160:161], v226 offset:16640
    ds_read_b64_tr_b16 v[162:163], v226 offset:24832
    s_waitcnt lgkmcnt(6)
    v_mfma_f32_16x16x32_bf16 a[72:75], v[176:179], v[116:119], a[72:75]
    v_exp_f32 v253, v253
    v_mfma_f32_16x16x32_bf16 a[76:79], v[176:179], v[120:123], a[76:79]
    v_add_f32 v242, v242, v250
    v_mfma_f32_16x16x32_bf16 a[80:83], v[176:179], v[124:127], a[80:83]
    v_add_f32 v242, v242, v251
    ds_read_b64_tr_b16 v[164:165], v227 offset:16640
    ds_read_b64_tr_b16 v[166:167], v227 offset:24832
    v_mfma_f32_16x16x32_bf16 a[84:87], v[180:183], v[116:119], a[84:87]
    v_cvt_pk_bf16_f32 v131, v250, v251
    v_mfma_f32_16x16x32_bf16 a[88:91], v[180:183], v[120:123], a[88:91]
    v_mfma_f32_16x16x32_bf16 a[92:95], v[180:183], v[124:127], a[92:95]
    v_fma_f32 v250, v76, s24, v238
    ds_read_b64_tr_b16 v[168:169], v228 offset:16640
    ds_read_b64_tr_b16 v[170:171], v228 offset:24832
    s_waitcnt lgkmcnt(6)
    v_mfma_f32_16x16x32_bf16 a[96:99], v[152:155], v[116:119], a[96:99]
    v_fma_f32 v251, v77, s24, v238
    v_mfma_f32_16x16x32_bf16 a[100:103], v[152:155], v[120:123], a[100:103]
    v_exp_f32 v248, v248
    v_mfma_f32_16x16x32_bf16 a[104:107], v[152:155], v[124:127], a[104:107]
    v_exp_f32 v249, v249
    ds_read_b64_tr_b16 v[172:173], v229 offset:16640
    ds_read_b64_tr_b16 v[174:175], v229 offset:24832
    v_mfma_f32_16x16x32_bf16 a[108:111], v[156:159], v[116:119], a[108:111]
    v_add_f32 v243, v243, v252
    v_mfma_f32_16x16x32_bf16 a[112:115], v[156:159], v[120:123], a[112:115]
    v_mfma_f32_16x16x32_bf16 a[116:119], v[156:159], v[124:127], a[116:119]
    v_add_f32 v243, v243, v253
    ds_read_b64_tr_b16 v[176:177], v230 offset:16640
    ds_read_b64_tr_b16 v[178:179], v230 offset:24832
    s_waitcnt lgkmcnt(6)
    v_mfma_f32_16x16x32_bf16 a[120:123], v[160:163], v[116:119], a[120:123]
    v_cvt_pk_bf16_f32 v134, v252, v253
    v_mfma_f32_16x16x32_bf16 a[124:127], v[160:163], v[120:123], a[124:127]
    v_fma_f32 v252, v78, s24, v238
    v_mfma_f32_16x16x32_bf16 a[128:131], v[160:163], v[124:127], a[128:131]
    v_fma_f32 v253, v79, s24, v238
    ds_read_b64_tr_b16 v[180:181], v231 offset:16640
    ds_read_b64_tr_b16 v[182:183], v231 offset:24832
    v_mfma_f32_16x16x32_bf16 a[132:135], v[164:167], v[116:119], a[132:135]
    v_exp_f32 v250, v250
    v_mfma_f32_16x16x32_bf16 a[136:139], v[164:167], v[120:123], a[136:139]
    v_exp_f32 v251, v251
    v_mfma_f32_16x16x32_bf16 a[140:143], v[164:167], v[124:127], a[140:143]
    s_waitcnt lgkmcnt(4)
    v_mfma_f32_16x16x32_bf16 a[144:147], v[168:171], v[116:119], a[144:147]
    v_add_f32 v243, v243, v248
    v_mfma_f32_16x16x32_bf16 a[148:151], v[168:171], v[120:123], a[148:151]
    v_add_f32 v243, v243, v249
    v_mfma_f32_16x16x32_bf16 a[152:155], v[168:171], v[124:127], a[152:155]
    v_cvt_pk_bf16_f32 v135, v248, v249
    v_mfma_f32_16x16x32_bf16 a[156:159], v[172:175], v[116:119], a[156:159]
    v_exp_f32 v252, v252
    v_mfma_f32_16x16x32_bf16 a[160:163], v[172:175], v[120:123], a[160:163]
    v_exp_f32 v253, v253
    v_mfma_f32_16x16x32_bf16 a[164:167], v[172:175], v[124:127], a[164:167]
    s_waitcnt lgkmcnt(0)
    v_mfma_f32_16x16x32_bf16 a[168:171], v[176:179], v[116:119], a[168:171]
    v_add_f32 v244, v244, v250
    v_mfma_f32_16x16x32_bf16 a[172:175], v[176:179], v[120:123], a[172:175]
    v_add_f32 v244, v244, v251
    v_mfma_f32_16x16x32_bf16 a[176:179], v[176:179], v[124:127], a[176:179]
    v_cvt_pk_bf16_f32 v138, v250, v251
    v_mfma_f32_16x16x32_bf16 a[180:183], v[180:183], v[116:119], a[180:183]
    v_add_f32 v244, v244, v252
    v_mfma_f32_16x16x32_bf16 a[184:187], v[180:183], v[120:123], a[184:187]
    v_add_f32 v244, v244, v253
    v_mfma_f32_16x16x32_bf16 a[188:191], v[180:183], v[124:127], a[188:191]
    v_cvt_pk_bf16_f32 v139, v252, v253
    s_waitcnt vmcnt(0)
    s_barrier
    ds_read_b64_tr_b16 v[152:153], v224 offset:32768
    ds_read_b64_tr_b16 v[154:155], v224 offset:40960
    ds_read_b64_tr_b16 v[156:157], v225 offset:32768
    ds_read_b64_tr_b16 v[158:159], v225 offset:40960
    ds_read_b64_tr_b16 v[160:161], v226 offset:32768
    ds_read_b64_tr_b16 v[162:163], v226 offset:40960
    ds_read_b64_tr_b16 v[164:165], v227 offset:32768
    ds_read_b64_tr_b16 v[166:167], v227 offset:40960
    v_fma_f32 v248, v80, s24, v236
    v_fma_f32 v249, v81, s24, v236
    v_fma_f32 v250, v82, s24, v236
    v_fma_f32 v251, v83, s24, v236
    v_exp_f32 v248, v248
    v_exp_f32 v249, v249
    v_fma_f32 v252, v84, s24, v237
    v_fma_f32 v253, v85, s24, v237
    v_exp_f32 v250, v250
    v_exp_f32 v251, v251
    v_add_f32 v245, v248, v249
    v_cvt_pk_bf16_f32 v140, v248, v249
    v_fma_f32 v248, v86, s24, v237
    v_fma_f32 v249, v87, s24, v237
    v_exp_f32 v252, v252
    v_exp_f32 v253, v253
    v_add_f32 v245, v245, v250
    v_add_f32 v245, v245, v251
    v_cvt_pk_bf16_f32 v141, v250, v251
    v_fma_f32 v250, v88, s24, v238
    v_fma_f32 v251, v89, s24, v238
    v_exp_f32 v248, v248
    v_exp_f32 v249, v249
    v_add_f32 v246, v252, v253
    v_cvt_pk_bf16_f32 v144, v252, v253
    v_fma_f32 v252, v90, s24, v238
    v_fma_f32 v253, v91, s24, v238
    v_exp_f32 v250, v250
    v_exp_f32 v251, v251
    v_add_f32 v246, v246, v248
    v_add_f32 v246, v246, v249
    v_cvt_pk_bf16_f32 v145, v248, v249
    v_fma_f32 v248, v92, s24, v236
    v_fma_f32 v249, v93, s24, v236
    v_exp_f32 v252, v252
    v_exp_f32 v253, v253
    v_add_f32 v247, v250, v251
    v_cvt_pk_bf16_f32 v148, v250, v251
    v_fma_f32 v250, v94, s24, v236
    v_fma_f32 v251, v95, s24, v236
    v_exp_f32 v248, v248
    v_exp_f32 v249, v249
    v_add_f32 v247, v247, v252
    v_add_f32 v247, v247, v253
    v_cvt_pk_bf16_f32 v149, v252, v253
    v_fma_f32 v252, v96, s24, v237
    v_fma_f32 v253, v97, s24, v237
    v_exp_f32 v250, v250
    v_exp_f32 v251, v251
    v_add_f32 v245, v245, v248
    v_add_f32 v245, v245, v249
    v_cvt_pk_bf16_f32 v142, v248, v249
    v_fma_f32 v248, v98, s24, v237
    v_fma_f32 v249, v99, s24, v237
    v_exp_f32 v252, v252
    v_exp_f32 v253, v253
    v_add_f32 v245, v245, v250
    v_add_f32 v245, v245, v251
    v_cvt_pk_bf16_f32 v143, v250, v251
    v_fma_f32 v250, v100, s24, v238
    v_fma_f32 v251, v101, s24, v238
    v_exp_f32 v248, v248
    v_exp_f32 v249, v249
    v_add_f32 v246, v246, v252
    v_add_f32 v246, v246, v253
    v_cvt_pk_bf16_f32 v146, v252, v253
    v_fma_f32 v252, v102, s24, v238
    v_fma_f32 v253, v103, s24, v238
    v_exp_f32 v250, v250
    v_exp_f32 v251, v251
    v_add_f32 v246, v246, v248
    v_add_f32 v246, v246, v249
    v_cvt_pk_bf16_f32 v147, v248, v249
    v_exp_f32 v252, v252
    v_exp_f32 v253, v253
    v_add_f32 v247, v247, v250
    v_add_f32 v247, v247, v251
    v_cvt_pk_bf16_f32 v150, v250, v251
    v_add_f32 v247, v247, v252
    v_add_f32 v247, v247, v253
    v_cvt_pk_bf16_f32 v151, v252, v253
    v_add_f32 v254, v242, v245
    v_add_f32 v255, v243, v246
    v_add_f32 v1, v244, v247
    v_max3_f32 v5, v254, v255, v1
    v_cmp_nge_f32 vcc, s25, v5
    s_nop 4
    s_cbranch_vccnz L_slow_t1
L_back_t1:
    v_add_f32 v239, v239, v254
    v_add_f32 v240, v240, v255
    v_add_f32 v241, v241, v1
    ds_read_b64_tr_b16 v[168:169], v228 offset:32768
    ds_read_b64_tr_b16 v[170:171], v228 offset:40960
    s_waitcnt lgkmcnt(6)
    v_mfma_f32_16x16x32_bf16 a[0:3], v[152:155], v[128:131], a[0:3]
    v_mfma_f32_16x16x32_bf16 a[4:7], v[152:155], v[132:135], a[4:7]
    v_mfma_f32_16x16x32_bf16 a[8:11], v[152:155], v[136:139], a[8:11]
    ds_read_b64_tr_b16 v[172:173], v229 offset:32768
    ds_read_b64_tr_b16 v[174:175], v229 offset:40960
    v_mfma_f32_16x16x32_bf16 a[12:15], v[156:159], v[128:131], a[12:15]
    v_mfma_f32_16x16x32_bf16 a[16:19], v[156:159], v[132:135], a[16:19]
    v_mfma_f32_16x16x32_bf16 a[20:23], v[156:159], v[136:139], a[20:23]
    ds_read_b64_tr_b16 v[176:177], v230 offset:32768
    ds_read_b64_tr_b16 v[178:179], v230 offset:40960
    s_waitcnt lgkmcnt(6)
    v_mfma_f32_16x16x32_bf16 a[24:27], v[160:163], v[128:131], a[24:27]
    v_mfma_f32_16x16x32_bf16 a[28:31], v[160:163], v[132:135], a[28:31]
    v_mfma_f32_16x16x32_bf16 a[32:35], v[160:163], v[136:139], a[32:35]
    ds_read_b64_tr_b16 v[180:181], v231 offset:32768
    ds_read_b64_tr_b16 v[182:183], v231 offset:40960
    v_mfma_f32_16x16x32_bf16 a[36:39], v[164:167], v[128:131], a[36:39]
    v_mfma_f32_16x16x32_bf16 a[40:43], v[164:167], v[132:135], a[40:43]
    v_mfma_f32_16x16x32_bf16 a[44:47], v[164:167], v[136:139], a[44:47]
    ds_read_b64_tr_b16 v[152:153], v224 offset:33024
    ds_read_b64_tr_b16 v[154:155], v224 offset:41216
    s_waitcnt lgkmcnt(6)
    v_mfma_f32_16x16x32_bf16 a[48:51], v[168:171], v[128:131], a[48:51]
    v_mfma_f32_16x16x32_bf16 a[52:55], v[168:171], v[132:135], a[52:55]
    v_mfma_f32_16x16x32_bf16 a[56:59], v[168:171], v[136:139], a[56:59]
    ds_read_b64_tr_b16 v[156:157], v225 offset:33024
    ds_read_b64_tr_b16 v[158:159], v225 offset:41216
    v_mfma_f32_16x16x32_bf16 a[60:63], v[172:175], v[128:131], a[60:63]
    v_mfma_f32_16x16x32_bf16 a[64:67], v[172:175], v[132:135], a[64:67]
    v_mfma_f32_16x16x32_bf16 a[68:71], v[172:175], v[136:139], a[68:71]
    ds_read_b64_tr_b16 v[160:161], v226 offset:33024
    ds_read_b64_tr_b16 v[162:163], v226 offset:41216
    s_waitcnt lgkmcnt(6)
    v_mfma_f32_16x16x32_bf16 a[72:75], v[176:179], v[128:131], a[72:75]
    v_mfma_f32_16x16x32_bf16 a[76:79], v[176:179], v[132:135], a[76:79]
    v_mfma_f32_16x16x32_bf16 a[80:83], v[176:179], v[136:139], a[80:83]
    ds_read_b64_tr_b16 v[164:165], v227 offset:33024
    ds_read_b64_tr_b16 v[166:167], v227 offset:41216
    v_mfma_f32_16x16x32_bf16 a[84:87], v[180:183], v[128:131], a[84:87]
    v_mfma_f32_16x16x32_bf16 a[88:91], v[180:183], v[132:135], a[88:91]
    v_mfma_f32_16x16x32_bf16 a[92:95], v[180:183], v[136:139], a[92:95]
    ds_read_b64_tr_b16 v[168:169], v228 offset:33024
    ds_read_b64_tr_b16 v[170:171], v228 offset:41216
    s_waitcnt lgkmcnt(6)
    v_mfma_f32_16x16x32_bf16 a[96:99], v[152:155], v[128:131], a[96:99]
    v_mfma_f32_16x16x32_bf16 a[100:103], v[152:155], v[132:135], a[100:103]
    v_mfma_f32_16x16x32_bf16 a[104:107], v[152:155], v[136:139], a[104:107]
    ds_read_b64_tr_b16 v[172:173], v229 offset:33024
    ds_read_b64_tr_b16 v[174:175], v229 offset:41216
    v_mfma_f32_16x16x32_bf16 a[108:111], v[156:159], v[128:131], a[108:111]
    v_mfma_f32_16x16x32_bf16 a[112:115], v[156:159], v[132:135], a[112:115]
    v_mfma_f32_16x16x32_bf16 a[116:119], v[156:159], v[136:139], a[116:119]
    ds_read_b64_tr_b16 v[176:177], v230 offset:33024
    ds_read_b64_tr_b16 v[178:179], v230 offset:41216
    s_waitcnt lgkmcnt(6)
    v_mfma_f32_16x16x32_bf16 a[120:123], v[160:163], v[128:131], a[120:123]
    v_mfma_f32_16x16x32_bf16 a[124:127], v[160:163], v[132:135], a[124:127]
    v_mfma_f32_16x16x32_bf16 a[128:131], v[160:163], v[136:139], a[128:131]
    ds_read_b64_tr_b16 v[180:181], v231 offset:33024
    ds_read_b64_tr_b16 v[182:183], v231 offset:41216
    v_mfma_f32_16x16x32_bf16 a[132:135], v[164:167], v[128:131], a[132:135]
    v_mfma_f32_16x16x32_bf16 a[136:139], v[164:167], v[132:135], a[136:139]
    v_mfma_f32_16x16x32_bf16 a[140:143], v[164:167], v[136:139], a[140:143]
    ds_read_b64_tr_b16 v[152:153], v224 offset:49152
    ds_read_b64_tr_b16 v[154:155], v224 offset:57344
    s_waitcnt lgkmcnt(6)
    v_mfma_f32_16x16x32_bf16 a[144:147], v[168:171], v[128:131], a[144:147]
    v_mfma_f32_16x16x32_bf16 a[148:151], v[168:171], v[132:135], a[148:151]
    v_mfma_f32_16x16x32_bf16 a[152:155], v[168:171], v[136:139], a[152:155]
    ds_read_b64_tr_b16 v[156:157], v225 offset:49152
    ds_read_b64_tr_b16 v[158:159], v225 offset:57344
    v_mfma_f32_16x16x32_bf16 a[156:159], v[172:175], v[128:131], a[156:159]
    v_mfma_f32_16x16x32_bf16 a[160:163], v[172:175], v[132:135], a[160:163]
    v_mfma_f32_16x16x32_bf16 a[164:167], v[172:175], v[136:139], a[164:167]
    ds_read_b64_tr_b16 v[160:161], v226 offset:49152
    ds_read_b64_tr_b16 v[162:163], v226 offset:57344
    s_waitcnt lgkmcnt(6)
    v_mfma_f32_16x16x32_bf16 a[168:171], v[176:179], v[128:131], a[168:171]
    v_mfma_f32_16x16x32_bf16 a[172:175], v[176:179], v[132:135], a[172:175]
    v_mfma_f32_16x16x32_bf16 a[176:179], v[176:179], v[136:139], a[176:179]
    ds_read_b64_tr_b16 v[164:165], v227 offset:49152
    ds_read_b64_tr_b16 v[166:167], v227 offset:57344
    v_mfma_f32_16x16x32_bf16 a[180:183], v[180:183], v[128:131], a[180:183]
    v_mfma_f32_16x16x32_bf16 a[184:187], v[180:183], v[132:135], a[184:187]
    v_mfma_f32_16x16x32_bf16 a[188:191], v[180:183], v[136:139], a[188:191]
    ds_read_b64_tr_b16 v[168:169], v228 offset:49152
    ds_read_b64_tr_b16 v[170:171], v228 offset:57344
    s_waitcnt lgkmcnt(6)
    v_mfma_f32_16x16x32_bf16 a[0:3], v[152:155], v[140:143], a[0:3]
    v_mfma_f32_16x16x32_bf16 a[4:7], v[152:155], v[144:147], a[4:7]
    v_mfma_f32_16x16x32_bf16 a[8:11], v[152:155], v[148:151], a[8:11]
    ds_read_b64_tr_b16 v[172:173], v229 offset:49152
    ds_read_b64_tr_b16 v[174:175], v229 offset:57344
    v_mfma_f32_16x16x32_bf16 a[12:15], v[156:159], v[140:143], a[12:15]
    v_mfma_f32_16x16x32_bf16 a[16:19], v[156:159], v[144:147], a[16:19]
    v_mfma_f32_16x16x32_bf16 a[20:23], v[156:159], v[148:151], a[20:23]
    ds_read_b64_tr_b16 v[176:177], v230 offset:49152
    ds_read_b64_tr_b16 v[178:179], v230 offset:57344
    s_waitcnt lgkmcnt(6)
    v_mfma_f32_16x16x32_bf16 a[24:27], v[160:163], v[140:143], a[24:27]
    v_mfma_f32_16x16x32_bf16 a[28:31], v[160:163], v[144:147], a[28:31]
    v_mfma_f32_16x16x32_bf16 a[32:35], v[160:163], v[148:151], a[32:35]
    ds_read_b64_tr_b16 v[180:181], v231 offset:49152
    ds_read_b64_tr_b16 v[182:183], v231 offset:57344
    v_mfma_f32_16x16x32_bf16 a[36:39], v[164:167], v[140:143], a[36:39]
    v_mfma_f32_16x16x32_bf16 a[40:43], v[164:167], v[144:147], a[40:43]
    v_mfma_f32_16x16x32_bf16 a[44:47], v[164:167], v[148:151], a[44:47]
    ds_read_b64_tr_b16 v[152:153], v224 offset:49408
    ds_read_b64_tr_b16 v[154:155], v224 offset:57600
    s_waitcnt lgkmcnt(6)
    v_mfma_f32_16x16x32_bf16 a[48:51], v[168:171], v[140:143], a[48:51]
    v_mfma_f32_16x16x32_bf16 a[52:55], v[168:171], v[144:147], a[52:55]
    v_mfma_f32_16x16x32_bf16 a[56:59], v[168:171], v[148:151], a[56:59]
    ds_read_b64_tr_b16 v[156:157], v225 offset:49408
    ds_read_b64_tr_b16 v[158:159], v225 offset:57600
    v_mfma_f32_16x16x32_bf16 a[60:63], v[172:175], v[140:143], a[60:63]
    v_mfma_f32_16x16x32_bf16 a[64:67], v[172:175], v[144:147], a[64:67]
    v_mfma_f32_16x16x32_bf16 a[68:71], v[172:175], v[148:151], a[68:71]
    ds_read_b64_tr_b16 v[160:161], v226 offset:49408
    ds_read_b64_tr_b16 v[162:163], v226 offset:57600
    s_waitcnt lgkmcnt(6)
    v_mfma_f32_16x16x32_bf16 a[72:75], v[176:179], v[140:143], a[72:75]
    v_mfma_f32_16x16x32_bf16 a[76:79], v[176:179], v[144:147], a[76:79]
    v_mfma_f32_16x16x32_bf16 a[80:83], v[176:179], v[148:151], a[80:83]
    ds_read_b64_tr_b16 v[164:165], v227 offset:49408
    ds_read_b64_tr_b16 v[166:167], v227 offset:57600
    v_mfma_f32_16x16x32_bf16 a[84:87], v[180:183], v[140:143], a[84:87]
    v_mfma_f32_16x16x32_bf16 a[88:91], v[180:183], v[144:147], a[88:91]
    v_mfma_f32_16x16x32_bf16 a[92:95], v[180:183], v[148:151], a[92:95]
    ds_read_b64_tr_b16 v[168:169], v228 offset:49408
    ds_read_b64_tr_b16 v[170:171], v228 offset:57600
    s_waitcnt lgkmcnt(6)
    v_mfma_f32_16x16x32_bf16 a[96:99], v[152:155], v[140:143], a[96:99]
    v_mfma_f32_16x16x32_bf16 a[100:103], v[152:155], v[144:147], a[100:103]
    v_mfma_f32_16x16x32_bf16 a[104:107], v[152:155], v[148:151], a[104:107]
    ds_read_b64_tr_b16 v[172:173], v229 offset:49408
    ds_read_b64_tr_b16 v[174:175], v229 offset:57600
    v_mfma_f32_16x16x32_bf16 a[108:111], v[156:159], v[140:143], a[108:111]
    v_mfma_f32_16x16x32_bf16 a[112:115], v[156:159], v[144:147], a[112:115]
    v_mfma_f32_16x16x32_bf16 a[116:119], v[156:159], v[148:151], a[116:119]
    ds_read_b64_tr_b16 v[176:177], v230 offset:49408
    ds_read_b64_tr_b16 v[178:179], v230 offset:57600
    s_waitcnt lgkmcnt(6)
    v_mfma_f32_16x16x32_bf16 a[120:123], v[160:163], v[140:143], a[120:123]
    v_mfma_f32_16x16x32_bf16 a[124:127], v[160:163], v[144:147], a[124:127]
    v_mfma_f32_16x16x32_bf16 a[128:131], v[160:163], v[148:151], a[128:131]
    ds_read_b64_tr_b16 v[180:181], v231 offset:49408
    ds_read_b64_tr_b16 v[182:183], v231 offset:57600
    v_mfma_f32_16x16x32_bf16 a[132:135], v[164:167], v[140:143], a[132:135]
    v_mfma_f32_16x16x32_bf16 a[136:139], v[164:167], v[144:147], a[136:139]
    v_mfma_f32_16x16x32_bf16 a[140:143], v[164:167], v[148:151], a[140:143]
    s_waitcnt lgkmcnt(4)
    v_mfma_f32_16x16x32_bf16 a[144:147], v[168:171], v[140:143], a[144:147]
    v_mfma_f32_16x16x32_bf16 a[148:151], v[168:171], v[144:147], a[148:151]
    v_mfma_f32_16x16x32_bf16 a[152:155], v[168:171], v[148:151], a[152:155]
    v_mfma_f32_16x16x32_bf16 a[156:159], v[172:175], v[140:143], a[156:159]
    v_mfma_f32_16x16x32_bf16 a[160:163], v[172:175], v[144:147], a[160:163]
    v_mfma_f32_16x16x32_bf16 a[164:167], v[172:175], v[148:151], a[164:167]
    s_waitcnt lgkmcnt(0)
    v_mfma_f32_16x16x32_bf16 a[168:171], v[176:179], v[140:143], a[168:171]
    v_mfma_f32_16x16x32_bf16 a[172:175], v[176:179], v[144:147], a[172:175]
    v_mfma_f32_16x16x32_bf16 a[176:179], v[176:179], v[148:151], a[176:179]
    v_mfma_f32_16x16x32_bf16 a[180:183], v[180:183], v[140:143], a[180:183]
    v_mfma_f32_16x16x32_bf16 a[184:187], v[180:183], v[144:147], a[184:187]
    v_mfma_f32_16x16x32_bf16 a[188:191], v[180:183], v[148:151], a[188:191]
    s_nop 7
    s_nop 1
    v_mov_b32 v254, v239
    v_mov_b32 v255, v239
    s_nop 1
    v_permlane32_swap_b32 v254, v255
    v_add_f32 v254, v254, v255
    v_mov_b32 v255, v254
    s_nop 1
    v_permlane16_swap_b32 v254, v255
    v_add_f32 v254, v254, v255
    v_rcp_f32 v248, v254
    v_mov_b32 v254, v240
    v_mov_b32 v255, v240
    s_nop 1
    v_permlane32_swap_b32 v254, v255
    v_add_f32 v254, v254, v255
    v_mov_b32 v255, v254
    s_nop 1
    v_permlane16_swap_b32 v254, v255
    v_add_f32 v254, v254, v255
    v_rcp_f32 v249, v254
    v_mov_b32 v254, v241
    v_mov_b32 v255, v241
    s_nop 1
    v_permlane32_swap_b32 v254, v255
    v_add_f32 v254, v254, v255
    v_mov_b32 v255, v254
    s_nop 1
    v_permlane16_swap_b32 v254, v255
    v_add_f32 v254, v254, v255
    v_rcp_f32 v250, v254
    v_and_b32 v5, 15, v0
    v_lshrrev_b32 v6, 4, v0
    v_lshlrev_b32 v7, 9, v5
    v_and_b32 v1, 1, v6
    v_lshl_add_u32 v7, v1, 5, v7
    v_lshrrev_b32 v1, 1, v6
    v_lshl_add_u32 v7, v1, 4, v7
    s_add_u32 s33, s32, 0
    v_accvgpr_read_b32 v8, a0
    v_accvgpr_read_b32 v9, a1
    v_accvgpr_read_b32 v10, a2
    v_accvgpr_read_b32 v11, a3
    v_accvgpr_read_b32 v12, a12
    v_accvgpr_read_b32 v13, a13
    v_accvgpr_read_b32 v14, a14
    v_accvgpr_read_b32 v15, a15
    v_mul_f32 v8, v8, v248
    v_mul_f32 v9, v9, v248
    v_mul_f32 v10, v10, v248
    v_mul_f32 v11, v11, v248
    v_mul_f32 v12, v12, v248
    v_mul_f32 v13, v13, v248
    v_mul_f32 v14, v14, v248
    v_mul_f32 v15, v15, v248
    v_cvt_pk_bf16_f32 v8, v8, v9
    v_cvt_pk_bf16_f32 v9, v10, v11
    v_cvt_pk_bf16_f32 v10, v12, v13
    v_cvt_pk_bf16_f32 v11, v14, v15
    s_nop 1
    v_permlane16_swap_b32 v8, v10
    v_permlane16_swap_b32 v9, v11
    buffer_store_dwordx4 v[8:11], v7, s[20:23], s33 offen offset:0
    v_accvgpr_read_b32 v16, a24
    v_accvgpr_read_b32 v17, a25
    v_accvgpr_read_b32 v18, a26
    v_accvgpr_read_b32 v19, a27
    v_accvgpr_read_b32 v20, a36
    v_accvgpr_read_b32 v21, a37
    v_accvgpr_read_b32 v22, a38
    v_accvgpr_read_b32 v23, a39
    v_mul_f32 v16, v16, v248
    v_mul_f32 v17, v17, v248
    v_mul_f32 v18, v18, v248
    v_mul_f32 v19, v19, v248
    v_mul_f32 v20, v20, v248
    v_mul_f32 v21, v21, v248
    v_mul_f32 v22, v22, v248
    v_mul_f32 v23, v23, v248
    v_cvt_pk_bf16_f32 v16, v16, v17
    v_cvt_pk_bf16_f32 v17, v18, v19
    v_cvt_pk_bf16_f32 v18, v20, v21
    v_cvt_pk_bf16_f32 v19, v22, v23
    s_nop 1
    v_permlane16_swap_b32 v16, v18
    v_permlane16_swap_b32 v17, v19
    buffer_store_dwordx4 v[16:19], v7, s[20:23], s33 offen offset:64
    v_accvgpr_read_b32 v24, a48
    v_accvgpr_read_b32 v25, a49
    v_accvgpr_read_b32 v26, a50
    v_accvgpr_read_b32 v27, a51
    v_accvgpr_read_b32 v28, a60
    v_accvgpr_read_b32 v29, a61
    v_accvgpr_read_b32 v30, a62
    v_accvgpr_read_b32 v31, a63
    v_mul_f32 v24, v24, v248
    v_mul_f32 v25, v25, v248
    v_mul_f32 v26, v26, v248
    v_mul_f32 v27, v27, v248
    v_mul_f32 v28, v28, v248
    v_mul_f32 v29, v29, v248
    v_mul_f32 v30, v30, v248
    v_mul_f32 v31, v31, v248
    v_cvt_pk_bf16_f32 v24, v24, v25
    v_cvt_pk_bf16_f32 v25, v26, v27
    v_cvt_pk_bf16_f32 v26, v28, v29
    v_cvt_pk_bf16_f32 v27, v30, v31
    s_nop 1
    v_permlane16_swap_b32 v24, v26
    v_permlane16_swap_b32 v25, v27
    buffer_store_dwordx4 v[24:27], v7, s[20:23], s33 offen offset:128
    v_accvgpr_read_b32 v32, a72
    v_accvgpr_read_b32 v33, a73
    v_accvgpr_read_b32 v34, a74
    v_accvgpr_read_b32 v35, a75
    v_accvgpr_read_b32 v36, a84
    v_accvgpr_read_b32 v37, a85
    v_accvgpr_read_b32 v38, a86
    v_accvgpr_read_b32 v39, a87
    v_mul_f32 v32, v32, v248
    v_mul_f32 v33, v33, v248
    v_mul_f32 v34, v34, v248
    v_mul_f32 v35, v35, v248
    v_mul_f32 v36, v36, v248
    v_mul_f32 v37, v37, v248
    v_mul_f32 v38, v38, v248
    v_mul_f32 v39, v39, v248
    v_cvt_pk_bf16_f32 v32, v32, v33
    v_cvt_pk_bf16_f32 v33, v34, v35
    v_cvt_pk_bf16_f32 v34, v36, v37
    v_cvt_pk_bf16_f32 v35, v38, v39
    s_nop 1
    v_permlane16_swap_b32 v32, v34
    v_permlane16_swap_b32 v33, v35
    buffer_store_dwordx4 v[32:35], v7, s[20:23], s33 offen offset:192
    v_accvgpr_read_b32 v40, a96
    v_accvgpr_read_b32 v41, a97
    v_accvgpr_read_b32 v42, a98
    v_accvgpr_read_b32 v43, a99
    v_accvgpr_read_b32 v44, a108
    v_accvgpr_read_b32 v45, a109
    v_accvgpr_read_b32 v46, a110
    v_accvgpr_read_b32 v47, a111
    v_mul_f32 v40, v40, v248
    v_mul_f32 v41, v41, v248
    v_mul_f32 v42, v42, v248
    v_mul_f32 v43, v43, v248
    v_mul_f32 v44, v44, v248
    v_mul_f32 v45, v45, v248
    v_mul_f32 v46, v46, v248
    v_mul_f32 v47, v47, v248
    v_cvt_pk_bf16_f32 v40, v40, v41
    v_cvt_pk_bf16_f32 v41, v42, v43
    v_cvt_pk_bf16_f32 v42, v44, v45
    v_cvt_pk_bf16_f32 v43, v46, v47
    s_nop 1
    v_permlane16_swap_b32 v40, v42
    v_permlane16_swap_b32 v41, v43
    buffer_store_dwordx4 v[40:43], v7, s[20:23], s33 offen offset:256
    v_accvgpr_read_b32 v48, a120
    v_accvgpr_read_b32 v49, a121
    v_accvgpr_read_b32 v50, a122
    v_accvgpr_read_b32 v51, a123
    v_accvgpr_read_b32 v52, a132
    v_accvgpr_read_b32 v53, a133
    v_accvgpr_read_b32 v54, a134
    v_accvgpr_read_b32 v55, a135
    v_mul_f32 v48, v48, v248
    v_mul_f32 v49, v49, v248
    v_mul_f32 v50, v50, v248
    v_mul_f32 v51, v51, v248
    v_mul_f32 v52, v52, v248
    v_mul_f32 v53, v53, v248
    v_mul_f32 v54, v54, v248
    v_mul_f32 v55, v55, v248
    v_cvt_pk_bf16_f32 v48, v48, v49
    v_cvt_pk_bf16_f32 v49, v50, v51
    v_cvt_pk_bf16_f32 v50, v52, v53
    v_cvt_pk_bf16_f32 v51, v54, v55
    s_nop 1
    v_permlane16_swap_b32 v48, v50
    v_permlane16_swap_b32 v49, v51
    buffer_store_dwordx4 v[48:51], v7, s[20:23], s33 offen offset:320
    v_accvgpr_read_b32 v56, a144
    v_accvgpr_read_b32 v57, a145
    v_accvgpr_read_b32 v58, a146
    v_accvgpr_read_b32 v59, a147
    v_accvgpr_read_b32 v60, a156
    v_accvgpr_read_b32 v61, a157
    v_accvgpr_read_b32 v62, a158
    v_accvgpr_read_b32 v63, a159
    v_mul_f32 v56, v56, v248
    v_mul_f32 v57, v57, v248
    v_mul_f32 v58, v58, v248
    v_mul_f32 v59, v59, v248
    v_mul_f32 v60, v60, v248
    v_mul_f32 v61, v61, v248
    v_mul_f32 v62, v62, v248
    v_mul_f32 v63, v63, v248
    v_cvt_pk_bf16_f32 v56, v56, v57
    v_cvt_pk_bf16_f32 v57, v58, v59
    v_cvt_pk_bf16_f32 v58, v60, v61
    v_cvt_pk_bf16_f32 v59, v62, v63
    s_nop 1
    v_permlane16_swap_b32 v56, v58
    v_permlane16_swap_b32 v57, v59
    buffer_store_dwordx4 v[56:59], v7, s[20:23], s33 offen offset:384
    v_accvgpr_read_b32 v64, a168
    v_accvgpr_read_b32 v65, a169
    v_accvgpr_read_b32 v66, a170
    v_accvgpr_read_b32 v67, a171
    v_accvgpr_read_b32 v68, a180
    v_accvgpr_read_b32 v69, a181
    v_accvgpr_read_b32 v70, a182
    v_accvgpr_read_b32 v71, a183
    v_mul_f32 v64, v64, v248
    v_mul_f32 v65, v65, v248
    v_mul_f32 v66, v66, v248
    v_mul_f32 v67, v67, v248
    v_mul_f32 v68, v68, v248
    v_mul_f32 v69, v69, v248
    v_mul_f32 v70, v70, v248
    v_mul_f32 v71, v71, v248
    v_cvt_pk_bf16_f32 v64, v64, v65
    v_cvt_pk_bf16_f32 v65, v66, v67
    v_cvt_pk_bf16_f32 v66, v68, v69
    v_cvt_pk_bf16_f32 v67, v70, v71
    s_nop 1
    v_permlane16_swap_b32 v64, v66
    v_permlane16_swap_b32 v65, v67
    buffer_store_dwordx4 v[64:67], v7, s[20:23], s33 offen offset:448
    s_add_u32 s33, s32, 8192
    v_accvgpr_read_b32 v72, a4
    v_accvgpr_read_b32 v73, a5
    v_accvgpr_read_b32 v74, a6
    v_accvgpr_read_b32 v75, a7
    v_accvgpr_read_b32 v76, a16
    v_accvgpr_read_b32 v77, a17
    v_accvgpr_read_b32 v78, a18
    v_accvgpr_read_b32 v79, a19
    v_mul_f32 v72, v72, v249
    v_mul_f32 v73, v73, v249
    v_mul_f32 v74, v74, v249
    v_mul_f32 v75, v75, v249
    v_mul_f32 v76, v76, v249
    v_mul_f32 v77, v77, v249
    v_mul_f32 v78, v78, v249
    v_mul_f32 v79, v79, v249
    v_cvt_pk_bf16_f32 v72, v72, v73
    v_cvt_pk_bf16_f32 v73, v74, v75
    v_cvt_pk_bf16_f32 v74, v76, v77
    v_cvt_pk_bf16_f32 v75, v78, v79
    s_nop 1
    v_permlane16_swap_b32 v72, v74
    v_permlane16_swap_b32 v73, v75
    buffer_store_dwordx4 v[72:75], v7, s[20:23], s33 offen offset:0
    v_accvgpr_read_b32 v80, a28
    v_accvgpr_read_b32 v81, a29
    v_accvgpr_read_b32 v82, a30
    v_accvgpr_read_b32 v83, a31
    v_accvgpr_read_b32 v84, a40
    v_accvgpr_read_b32 v85, a41
    v_accvgpr_read_b32 v86, a42
    v_accvgpr_read_b32 v87, a43
    v_mul_f32 v80, v80, v249
    v_mul_f32 v81, v81, v249
    v_mul_f32 v82, v82, v249
    v_mul_f32 v83, v83, v249
    v_mul_f32 v84, v84, v249
    v_mul_f32 v85, v85, v249
    v_mul_f32 v86, v86, v249
    v_mul_f32 v87, v87, v249
    v_cvt_pk_bf16_f32 v80, v80, v81
    v_cvt_pk_bf16_f32 v81, v82, v83
    v_cvt_pk_bf16_f32 v82, v84, v85
    v_cvt_pk_bf16_f32 v83, v86, v87
    s_nop 1
    v_permlane16_swap_b32 v80, v82
    v_permlane16_swap_b32 v81, v83
    buffer_store_dwordx4 v[80:83], v7, s[20:23], s33 offen offset:64
    v_accvgpr_read_b32 v88, a52
    v_accvgpr_read_b32 v89, a53
    v_accvgpr_read_b32 v90, a54
    v_accvgpr_read_b32 v91, a55
    v_accvgpr_read_b32 v92, a64
    v_accvgpr_read_b32 v93, a65
    v_accvgpr_read_b32 v94, a66
    v_accvgpr_read_b32 v95, a67
    v_mul_f32 v88, v88, v249
    v_mul_f32 v89, v89, v249
    v_mul_f32 v90, v90, v249
    v_mul_f32 v91, v91, v249
    v_mul_f32 v92, v92, v249
    v_mul_f32 v93, v93, v249
    v_mul_f32 v94, v94, v249
    v_mul_f32 v95, v95, v249
    v_cvt_pk_bf16_f32 v88, v88, v89
    v_cvt_pk_bf16_f32 v89, v90, v91
    v_cvt_pk_bf16_f32 v90, v92, v93
    v_cvt_pk_bf16_f32 v91, v94, v95
    s_nop 1
    v_permlane16_swap_b32 v88, v90
    v_permlane16_swap_b32 v89, v91
    buffer_store_dwordx4 v[88:91], v7, s[20:23], s33 offen offset:128
    v_accvgpr_read_b32 v96, a76
    v_accvgpr_read_b32 v97, a77
    v_accvgpr_read_b32 v98, a78
    v_accvgpr_read_b32 v99, a79
    v_accvgpr_read_b32 v100, a88
    v_accvgpr_read_b32 v101, a89
    v_accvgpr_read_b32 v102, a90
    v_accvgpr_read_b32 v103, a91
    v_mul_f32 v96, v96, v249
    v_mul_f32 v97, v97, v249
    v_mul_f32 v98, v98, v249
    v_mul_f32 v99, v99, v249
    v_mul_f32 v100, v100, v249
    v_mul_f32 v101, v101, v249
    v_mul_f32 v102, v102, v249
    v_mul_f32 v103, v103, v249
    v_cvt_pk_bf16_f32 v96, v96, v97
    v_cvt_pk_bf16_f32 v97, v98, v99
    v_cvt_pk_bf16_f32 v98, v100, v101
    v_cvt_pk_bf16_f32 v99, v102, v103
    s_nop 1
    v_permlane16_swap_b32 v96, v98
    v_permlane16_swap_b32 v97, v99
    buffer_store_dwordx4 v[96:99], v7, s[20:23], s33 offen offset:192
    v_accvgpr_read_b32 v8, a100
    v_accvgpr_read_b32 v9, a101
    v_accvgpr_read_b32 v10, a102
    v_accvgpr_read_b32 v11, a103
    v_accvgpr_read_b32 v12, a112
    v_accvgpr_read_b32 v13, a113
    v_accvgpr_read_b32 v14, a114
    v_accvgpr_read_b32 v15, a115
    v_mul_f32 v8, v8, v249
    v_mul_f32 v9, v9, v249
    v_mul_f32 v10, v10, v249
    v_mul_f32 v11, v11, v249
    v_mul_f32 v12, v12, v249
    v_mul_f32 v13, v13, v249
    v_mul_f32 v14, v14, v249
    v_mul_f32 v15, v15, v249
    v_cvt_pk_bf16_f32 v8, v8, v9
    v_cvt_pk_bf16_f32 v9, v10, v11
    v_cvt_pk_bf16_f32 v10, v12, v13
    v_cvt_pk_bf16_f32 v11, v14, v15
    s_nop 1
    v_permlane16_swap_b32 v8, v10
    v_permlane16_swap_b32 v9, v11
    buffer_store_dwordx4 v[8:11], v7, s[20:23], s33 offen offset:256
    v_accvgpr_read_b32 v16, a124
    v_accvgpr_read_b32 v17, a125
    v_accvgpr_read_b32 v18, a126
    v_accvgpr_read_b32 v19, a127
    v_accvgpr_read_b32 v20, a136
    v_accvgpr_read_b32 v21, a137
    v_accvgpr_read_b32 v22, a138
    v_accvgpr_read_b32 v23, a139
    v_mul_f32 v16, v16, v249
    v_mul_f32 v17, v17, v249
    v_mul_f32 v18, v18, v249
    v_mul_f32 v19, v19, v249
    v_mul_f32 v20, v20, v249
    v_mul_f32 v21, v21, v249
    v_mul_f32 v22, v22, v249
    v_mul_f32 v23, v23, v249
    v_cvt_pk_bf16_f32 v16, v16, v17
    v_cvt_pk_bf16_f32 v17, v18, v19
    v_cvt_pk_bf16_f32 v18, v20, v21
    v_cvt_pk_bf16_f32 v19, v22, v23
    s_nop 1
    v_permlane16_swap_b32 v16, v18
    v_permlane16_swap_b32 v17, v19
    buffer_store_dwordx4 v[16:19], v7, s[20:23], s33 offen offset:320
    v_accvgpr_read_b32 v24, a148
    v_accvgpr_read_b32 v25, a149
    v_accvgpr_read_b32 v26, a150
    v_accvgpr_read_b32 v27, a151
    v_accvgpr_read_b32 v28, a160
    v_accvgpr_read_b32 v29, a161
    v_accvgpr_read_b32 v30, a162
    v_accvgpr_read_b32 v31, a163
    v_mul_f32 v24, v24, v249
    v_mul_f32 v25, v25, v249
    v_mul_f32 v26, v26, v249
    v_mul_f32 v27, v27, v249
    v_mul_f32 v28, v28, v249
    v_mul_f32 v29, v29, v249
    v_mul_f32 v30, v30, v249
    v_mul_f32 v31, v31, v249
    v_cvt_pk_bf16_f32 v24, v24, v25
    v_cvt_pk_bf16_f32 v25, v26, v27
    v_cvt_pk_bf16_f32 v26, v28, v29
    v_cvt_pk_bf16_f32 v27, v30, v31
    s_nop 1
    v_permlane16_swap_b32 v24, v26
    v_permlane16_swap_b32 v25, v27
    buffer_store_dwordx4 v[24:27], v7, s[20:23], s33 offen offset:384
    v_accvgpr_read_b32 v32, a172
    v_accvgpr_read_b32 v33, a173
    v_accvgpr_read_b32 v34, a174
    v_accvgpr_read_b32 v35, a175
    v_accvgpr_read_b32 v36, a184
    v_accvgpr_read_b32 v37, a185
    v_accvgpr_read_b32 v38, a186
    v_accvgpr_read_b32 v39, a187
    v_mul_f32 v32, v32, v249
    v_mul_f32 v33, v33, v249
    v_mul_f32 v34, v34, v249
    v_mul_f32 v35, v35, v249
    v_mul_f32 v36, v36, v249
    v_mul_f32 v37, v37, v249
    v_mul_f32 v38, v38, v249
    v_mul_f32 v39, v39, v249
    v_cvt_pk_bf16_f32 v32, v32, v33
    v_cvt_pk_bf16_f32 v33, v34, v35
    v_cvt_pk_bf16_f32 v34, v36, v37
    v_cvt_pk_bf16_f32 v35, v38, v39
    s_nop 1
    v_permlane16_swap_b32 v32, v34
    v_permlane16_swap_b32 v33, v35
    buffer_store_dwordx4 v[32:35], v7, s[20:23], s33 offen offset:448
    s_add_u32 s33, s32, 16384
    v_accvgpr_read_b32 v40, a8
    v_accvgpr_read_b32 v41, a9
    v_accvgpr_read_b32 v42, a10
    v_accvgpr_read_b32 v43, a11
    v_accvgpr_read_b32 v44, a20
    v_accvgpr_read_b32 v45, a21
    v_accvgpr_read_b32 v46, a22
    v_accvgpr_read_b32 v47, a23
    v_mul_f32 v40, v40, v250
    v_mul_f32 v41, v41, v250
    v_mul_f32 v42, v42, v250
    v_mul_f32 v43, v43, v250
    v_mul_f32 v44, v44, v250
    v_mul_f32 v45, v45, v250
    v_mul_f32 v46, v46, v250
    v_mul_f32 v47, v47, v250
    v_cvt_pk_bf16_f32 v40, v40, v41
    v_cvt_pk_bf16_f32 v41, v42, v43
    v_cvt_pk_bf16_f32 v42, v44, v45
    v_cvt_pk_bf16_f32 v43, v46, v47
    s_nop 1
    v_permlane16_swap_b32 v40, v42
    v_permlane16_swap_b32 v41, v43
    buffer_store_dwordx4 v[40:43], v7, s[20:23], s33 offen offset:0
    v_accvgpr_read_b32 v48, a32
    v_accvgpr_read_b32 v49, a33
    v_accvgpr_read_b32 v50, a34
    v_accvgpr_read_b32 v51, a35
    v_accvgpr_read_b32 v52, a44
    v_accvgpr_read_b32 v53, a45
    v_accvgpr_read_b32 v54, a46
    v_accvgpr_read_b32 v55, a47
    v_mul_f32 v48, v48, v250
    v_mul_f32 v49, v49, v250
    v_mul_f32 v50, v50, v250
    v_mul_f32 v51, v51, v250
    v_mul_f32 v52, v52, v250
    v_mul_f32 v53, v53, v250
    v_mul_f32 v54, v54, v250
    v_mul_f32 v55, v55, v250
    v_cvt_pk_bf16_f32 v48, v48, v49
    v_cvt_pk_bf16_f32 v49, v50, v51
    v_cvt_pk_bf16_f32 v50, v52, v53
    v_cvt_pk_bf16_f32 v51, v54, v55
    s_nop 1
    v_permlane16_swap_b32 v48, v50
    v_permlane16_swap_b32 v49, v51
    buffer_store_dwordx4 v[48:51], v7, s[20:23], s33 offen offset:64
    v_accvgpr_read_b32 v56, a56
    v_accvgpr_read_b32 v57, a57
    v_accvgpr_read_b32 v58, a58
    v_accvgpr_read_b32 v59, a59
    v_accvgpr_read_b32 v60, a68
    v_accvgpr_read_b32 v61, a69
    v_accvgpr_read_b32 v62, a70
    v_accvgpr_read_b32 v63, a71
    v_mul_f32 v56, v56, v250
    v_mul_f32 v57, v57, v250
    v_mul_f32 v58, v58, v250
    v_mul_f32 v59, v59, v250
    v_mul_f32 v60, v60, v250
    v_mul_f32 v61, v61, v250
    v_mul_f32 v62, v62, v250
    v_mul_f32 v63, v63, v250
    v_cvt_pk_bf16_f32 v56, v56, v57
    v_cvt_pk_bf16_f32 v57, v58, v59
    v_cvt_pk_bf16_f32 v58, v60, v61
    v_cvt_pk_bf16_f32 v59, v62, v63
    s_nop 1
    v_permlane16_swap_b32 v56, v58
    v_permlane16_swap_b32 v57, v59
    buffer_store_dwordx4 v[56:59], v7, s[20:23], s33 offen offset:128
    v_accvgpr_read_b32 v64, a80
    v_accvgpr_read_b32 v65, a81
    v_accvgpr_read_b32 v66, a82
    v_accvgpr_read_b32 v67, a83
    v_accvgpr_read_b32 v68, a92
    v_accvgpr_read_b32 v69, a93
    v_accvgpr_read_b32 v70, a94
    v_accvgpr_read_b32 v71, a95
    v_mul_f32 v64, v64, v250
    v_mul_f32 v65, v65, v250
    v_mul_f32 v66, v66, v250
    v_mul_f32 v67, v67, v250
    v_mul_f32 v68, v68, v250
    v_mul_f32 v69, v69, v250
    v_mul_f32 v70, v70, v250
    v_mul_f32 v71, v71, v250
    v_cvt_pk_bf16_f32 v64, v64, v65
    v_cvt_pk_bf16_f32 v65, v66, v67
    v_cvt_pk_bf16_f32 v66, v68, v69
    v_cvt_pk_bf16_f32 v67, v70, v71
    s_nop 1
    v_permlane16_swap_b32 v64, v66
    v_permlane16_swap_b32 v65, v67
    buffer_store_dwordx4 v[64:67], v7, s[20:23], s33 offen offset:192
    v_accvgpr_read_b32 v72, a104
    v_accvgpr_read_b32 v73, a105
    v_accvgpr_read_b32 v74, a106
    v_accvgpr_read_b32 v75, a107
    v_accvgpr_read_b32 v76, a116
    v_accvgpr_read_b32 v77, a117
    v_accvgpr_read_b32 v78, a118
    v_accvgpr_read_b32 v79, a119
    v_mul_f32 v72, v72, v250
    v_mul_f32 v73, v73, v250
    v_mul_f32 v74, v74, v250
    v_mul_f32 v75, v75, v250
    v_mul_f32 v76, v76, v250
    v_mul_f32 v77, v77, v250
    v_mul_f32 v78, v78, v250
    v_mul_f32 v79, v79, v250
    v_cvt_pk_bf16_f32 v72, v72, v73
    v_cvt_pk_bf16_f32 v73, v74, v75
    v_cvt_pk_bf16_f32 v74, v76, v77
    v_cvt_pk_bf16_f32 v75, v78, v79
    s_nop 1
    v_permlane16_swap_b32 v72, v74
    v_permlane16_swap_b32 v73, v75
    buffer_store_dwordx4 v[72:75], v7, s[20:23], s33 offen offset:256
    v_accvgpr_read_b32 v80, a128
    v_accvgpr_read_b32 v81, a129
    v_accvgpr_read_b32 v82, a130
    v_accvgpr_read_b32 v83, a131
    v_accvgpr_read_b32 v84, a140
    v_accvgpr_read_b32 v85, a141
    v_accvgpr_read_b32 v86, a142
    v_accvgpr_read_b32 v87, a143
    v_mul_f32 v80, v80, v250
    v_mul_f32 v81, v81, v250
    v_mul_f32 v82, v82, v250
    v_mul_f32 v83, v83, v250
    v_mul_f32 v84, v84, v250
    v_mul_f32 v85, v85, v250
    v_mul_f32 v86, v86, v250
    v_mul_f32 v87, v87, v250
    v_cvt_pk_bf16_f32 v80, v80, v81
    v_cvt_pk_bf16_f32 v81, v82, v83
    v_cvt_pk_bf16_f32 v82, v84, v85
    v_cvt_pk_bf16_f32 v83, v86, v87
    s_nop 1
    v_permlane16_swap_b32 v80, v82
    v_permlane16_swap_b32 v81, v83
    buffer_store_dwordx4 v[80:83], v7, s[20:23], s33 offen offset:320
    v_accvgpr_read_b32 v88, a152
    v_accvgpr_read_b32 v89, a153
    v_accvgpr_read_b32 v90, a154
    v_accvgpr_read_b32 v91, a155
    v_accvgpr_read_b32 v92, a164
    v_accvgpr_read_b32 v93, a165
    v_accvgpr_read_b32 v94, a166
    v_accvgpr_read_b32 v95, a167
    v_mul_f32 v88, v88, v250
    v_mul_f32 v89, v89, v250
    v_mul_f32 v90, v90, v250
    v_mul_f32 v91, v91, v250
    v_mul_f32 v92, v92, v250
    v_mul_f32 v93, v93, v250
    v_mul_f32 v94, v94, v250
    v_mul_f32 v95, v95, v250
    v_cvt_pk_bf16_f32 v88, v88, v89
    v_cvt_pk_bf16_f32 v89, v90, v91
    v_cvt_pk_bf16_f32 v90, v92, v93
    v_cvt_pk_bf16_f32 v91, v94, v95
    s_nop 1
    v_permlane16_swap_b32 v88, v90
    v_permlane16_swap_b32 v89, v91
    buffer_store_dwordx4 v[88:91], v7, s[20:23], s33 offen offset:384
    v_accvgpr_read_b32 v96, a176
    v_accvgpr_read_b32 v97, a177
    v_accvgpr_read_b32 v98, a178
    v_accvgpr_read_b32 v99, a179
    v_accvgpr_read_b32 v100, a188
    v_accvgpr_read_b32 v101, a189
    v_accvgpr_read_b32 v102, a190
    v_accvgpr_read_b32 v103, a191
    v_mul_f32 v96, v96, v250
    v_mul_f32 v97, v97, v250
    v_mul_f32 v98, v98, v250
    v_mul_f32 v99, v99, v250
    v_mul_f32 v100, v100, v250
    v_mul_f32 v101, v101, v250
    v_mul_f32 v102, v102, v250
    v_mul_f32 v103, v103, v250
    v_cvt_pk_bf16_f32 v96, v96, v97
    v_cvt_pk_bf16_f32 v97, v98, v99
    v_cvt_pk_bf16_f32 v98, v100, v101
    v_cvt_pk_bf16_f32 v99, v102, v103
    s_nop 1
    v_permlane16_swap_b32 v96, v98
    v_permlane16_swap_b32 v97, v99
    buffer_store_dwordx4 v[96:99], v7, s[20:23], s33 offen offset:448
    s_endpgm
L_slow_l0:
    v_max3_f32 v254, v8, v9, v10
    v_max3_f32 v254, v254, v11, v20
    v_max3_f32 v254, v254, v21, v22
    v_max3_f32 v254, v254, v23, v32
    v_max3_f32 v254, v254, v33, v34
    v_max3_f32 v254, v254, v35, v44
    v_max3_f32 v254, v254, v45, v46
    v_max_f32 v254, v254, v47
    v_mov_b32 v255, v254
    s_nop 1
    v_permlane32_swap_b32 v254, v255
    v_max_f32 v254, v254, v255
    v_mov_b32 v255, v254
    s_nop 1
    v_permlane16_swap_b32 v254, v255
    v_max_f32 v254, v254, v255
    v_max_f32 v254, v254, v2
    v_sub_f32 v255, v2, v254
    v_mul_f32 v255, s24, v255
    v_exp_f32 v248, v255
    v_mov_b32 v2, v254
    v_mul_f32 v236, -v254, s24
    v_mul_f32 v239, v239, v248
    v_max3_f32 v254, v12, v13, v14
    v_max3_f32 v254, v254, v15, v24
    v_max3_f32 v254, v254, v25, v26
    v_max3_f32 v254, v254, v27, v36
    v_max3_f32 v254, v254, v37, v38
    v_max3_f32 v254, v254, v39, v48
    v_max3_f32 v254, v254, v49, v50
    v_max_f32 v254, v254, v51
    v_mov_b32 v255, v254
    s_nop 1
    v_permlane32_swap_b32 v254, v255
    v_max_f32 v254, v254, v255
    v_mov_b32 v255, v254
    s_nop 1
    v_permlane16_swap_b32 v254, v255
    v_max_f32 v254, v254, v255
    v_max_f32 v254, v254, v3
    v_sub_f32 v255, v3, v254
    v_mul_f32 v255, s24, v255
    v_exp_f32 v249, v255
    v_mov_b32 v3, v254
    v_mul_f32 v237, -v254, s24
    v_mul_f32 v240, v240, v249
    v_max3_f32 v254, v16, v17, v18
    v_max3_f32 v254, v254, v19, v28
    v_max3_f32 v254, v254, v29, v30
    v_max3_f32 v254, v254, v31, v40
    v_max3_f32 v254, v254, v41, v42
    v_max3_f32 v254, v254, v43, v52
    v_max3_f32 v254, v254, v53, v54
    v_max_f32 v254, v254, v55
    v_mov_b32 v255, v254
    s_nop 1
    v_permlane32_swap_b32 v254, v255
    v_max_f32 v254, v254, v255
    v_mov_b32 v255, v254
    s_nop 1
    v_permlane16_swap_b32 v254, v255
    v_max_f32 v254, v254, v255
    v_max_f32 v254, v254, v4
    v_sub_f32 v255, v4, v254
    v_mul_f32 v255, s24, v255
    v_exp_f32 v250, v255
    v_mov_b32 v4, v254
    v_mul_f32 v238, -v254, s24
    v_mul_f32 v241, v241, v250
    v_accvgpr_read_b32 v254, a0
    v_accvgpr_read_b32 v255, a1
    v_accvgpr_read_b32 v1, a2
    v_accvgpr_read_b32 v5, a3
    v_mul_f32 v254, v254, v248
    v_mul_f32 v255, v255, v248
    v_mul_f32 v1, v1, v248
    v_mul_f32 v5, v5, v248
    v_accvgpr_write_b32 a0, v254
    v_accvgpr_write_b32 a1, v255
    v_accvgpr_write_b32 a2, v1
    v_accvgpr_write_b32 a3, v5
    v_accvgpr_read_b32 v254, a4
    v_accvgpr_read_b32 v255, a5
    v_accvgpr_read_b32 v1, a6
    v_accvgpr_read_b32 v5, a7
    v_mul_f32 v254, v254, v249
    v_mul_f32 v255, v255, v249
    v_mul_f32 v1, v1, v249
    v_mul_f32 v5, v5, v249
    v_accvgpr_write_b32 a4, v254
    v_accvgpr_write_b32 a5, v255
    v_accvgpr_write_b32 a6, v1
    v_accvgpr_write_b32 a7, v5
    v_accvgpr_read_b32 v254, a8
    v_accvgpr_read_b32 v255, a9
    v_accvgpr_read_b32 v1, a10
    v_accvgpr_read_b32 v5, a11
    v_mul_f32 v254, v254, v250
    v_mul_f32 v255, v255, v250
    v_mul_f32 v1, v1, v250
    v_mul_f32 v5, v5, v250
    v_accvgpr_write_b32 a8, v254
    v_accvgpr_write_b32 a9, v255
    v_accvgpr_write_b32 a10, v1
    v_accvgpr_write_b32 a11, v5
    v_accvgpr_read_b32 v254, a12
    v_accvgpr_read_b32 v255, a13
    v_accvgpr_read_b32 v1, a14
    v_accvgpr_read_b32 v5, a15
    v_mul_f32 v254, v254, v248
    v_mul_f32 v255, v255, v248
    v_mul_f32 v1, v1, v248
    v_mul_f32 v5, v5, v248
    v_accvgpr_write_b32 a12, v254
    v_accvgpr_write_b32 a13, v255
    v_accvgpr_write_b32 a14, v1
    v_accvgpr_write_b32 a15, v5
    v_accvgpr_read_b32 v254, a16
    v_accvgpr_read_b32 v255, a17
    v_accvgpr_read_b32 v1, a18
    v_accvgpr_read_b32 v5, a19
    v_mul_f32 v254, v254, v249
    v_mul_f32 v255, v255, v249
    v_mul_f32 v1, v1, v249
    v_mul_f32 v5, v5, v249
    v_accvgpr_write_b32 a16, v254
    v_accvgpr_write_b32 a17, v255
    v_accvgpr_write_b32 a18, v1
    v_accvgpr_write_b32 a19, v5
    v_accvgpr_read_b32 v254, a20
    v_accvgpr_read_b32 v255, a21
    v_accvgpr_read_b32 v1, a22
    v_accvgpr_read_b32 v5, a23
    v_mul_f32 v254, v254, v250
    v_mul_f32 v255, v255, v250
    v_mul_f32 v1, v1, v250
    v_mul_f32 v5, v5, v250
    v_accvgpr_write_b32 a20, v254
    v_accvgpr_write_b32 a21, v255
    v_accvgpr_write_b32 a22, v1
    v_accvgpr_write_b32 a23, v5
    v_accvgpr_read_b32 v254, a24
    v_accvgpr_read_b32 v255, a25
    v_accvgpr_read_b32 v1, a26
    v_accvgpr_read_b32 v5, a27
    v_mul_f32 v254, v254, v248
    v_mul_f32 v255, v255, v248
    v_mul_f32 v1, v1, v248
    v_mul_f32 v5, v5, v248
    v_accvgpr_write_b32 a24, v254
    v_accvgpr_write_b32 a25, v255
    v_accvgpr_write_b32 a26, v1
    v_accvgpr_write_b32 a27, v5
    v_accvgpr_read_b32 v254, a28
    v_accvgpr_read_b32 v255, a29
    v_accvgpr_read_b32 v1, a30
    v_accvgpr_read_b32 v5, a31
    v_mul_f32 v254, v254, v249
    v_mul_f32 v255, v255, v249
    v_mul_f32 v1, v1, v249
    v_mul_f32 v5, v5, v249
    v_accvgpr_write_b32 a28, v254
    v_accvgpr_write_b32 a29, v255
    v_accvgpr_write_b32 a30, v1
    v_accvgpr_write_b32 a31, v5
    v_accvgpr_read_b32 v254, a32
    v_accvgpr_read_b32 v255, a33
    v_accvgpr_read_b32 v1, a34
    v_accvgpr_read_b32 v5, a35
    v_mul_f32 v254, v254, v250
    v_mul_f32 v255, v255, v250
    v_mul_f32 v1, v1, v250
    v_mul_f32 v5, v5, v250
    v_accvgpr_write_b32 a32, v254
    v_accvgpr_write_b32 a33, v255
    v_accvgpr_write_b32 a34, v1
    v_accvgpr_write_b32 a35, v5
    v_accvgpr_read_b32 v254, a36
    v_accvgpr_read_b32 v255, a37
    v_accvgpr_read_b32 v1, a38
    v_accvgpr_read_b32 v5, a39
    v_mul_f32 v254, v254, v248
    v_mul_f32 v255, v255, v248
    v_mul_f32 v1, v1, v248
    v_mul_f32 v5, v5, v248
    v_accvgpr_write_b32 a36, v254
    v_accvgpr_write_b32 a37, v255
    v_accvgpr_write_b32 a38, v1
    v_accvgpr_write_b32 a39, v5
    v_accvgpr_read_b32 v254, a40
    v_accvgpr_read_b32 v255, a41
    v_accvgpr_read_b32 v1, a42
    v_accvgpr_read_b32 v5, a43
    v_mul_f32 v254, v254, v249
    v_mul_f32 v255, v255, v249
    v_mul_f32 v1, v1, v249
    v_mul_f32 v5, v5, v249
    v_accvgpr_write_b32 a40, v254
    v_accvgpr_write_b32 a41, v255
    v_accvgpr_write_b32 a42, v1
    v_accvgpr_write_b32 a43, v5
    v_accvgpr_read_b32 v254, a44
    v_accvgpr_read_b32 v255, a45
    v_accvgpr_read_b32 v1, a46
    v_accvgpr_read_b32 v5, a47
    v_mul_f32 v254, v254, v250
    v_mul_f32 v255, v255, v250
    v_mul_f32 v1, v1, v250
    v_mul_f32 v5, v5, v250
    v_accvgpr_write_b32 a44, v254
    v_accvgpr_write_b32 a45, v255
    v_accvgpr_write_b32 a46, v1
    v_accvgpr_write_b32 a47, v5
    v_accvgpr_read_b32 v254, a48
    v_accvgpr_read_b32 v255, a49
    v_accvgpr_read_b32 v1, a50
    v_accvgpr_read_b32 v5, a51
    v_mul_f32 v254, v254, v248
    v_mul_f32 v255, v255, v248
    v_mul_f32 v1, v1, v248
    v_mul_f32 v5, v5, v248
    v_accvgpr_write_b32 a48, v254
    v_accvgpr_write_b32 a49, v255
    v_accvgpr_write_b32 a50, v1
    v_accvgpr_write_b32 a51, v5
    v_accvgpr_read_b32 v254, a52
    v_accvgpr_read_b32 v255, a53
    v_accvgpr_read_b32 v1, a54
    v_accvgpr_read_b32 v5, a55
    v_mul_f32 v254, v254, v249
    v_mul_f32 v255, v255, v249
    v_mul_f32 v1, v1, v249
    v_mul_f32 v5, v5, v249
    v_accvgpr_write_b32 a52, v254
    v_accvgpr_write_b32 a53, v255
    v_accvgpr_write_b32 a54, v1
    v_accvgpr_write_b32 a55, v5
    v_accvgpr_read_b32 v254, a56
    v_accvgpr_read_b32 v255, a57
    v_accvgpr_read_b32 v1, a58
    v_accvgpr_read_b32 v5, a59
    v_mul_f32 v254, v254, v250
    v_mul_f32 v255, v255, v250
    v_mul_f32 v1, v1, v250
    v_mul_f32 v5, v5, v250
    v_accvgpr_write_b32 a56, v254
    v_accvgpr_write_b32 a57, v255
    v_accvgpr_write_b32 a58, v1
    v_accvgpr_write_b32 a59, v5
    v_accvgpr_read_b32 v254, a60
    v_accvgpr_read_b32 v255, a61
    v_accvgpr_read_b32 v1, a62
    v_accvgpr_read_b32 v5, a63
    v_mul_f32 v254, v254, v248
    v_mul_f32 v255, v255, v248
    v_mul_f32 v1, v1, v248
    v_mul_f32 v5, v5, v248
    v_accvgpr_write_b32 a60, v254
    v_accvgpr_write_b32 a61, v255
    v_accvgpr_write_b32 a62, v1
    v_accvgpr_write_b32 a63, v5
    v_accvgpr_read_b32 v254, a64
    v_accvgpr_read_b32 v255, a65
    v_accvgpr_read_b32 v1, a66
    v_accvgpr_read_b32 v5, a67
    v_mul_f32 v254, v254, v249
    v_mul_f32 v255, v255, v249
    v_mul_f32 v1, v1, v249
    v_mul_f32 v5, v5, v249
    v_accvgpr_write_b32 a64, v254
    v_accvgpr_write_b32 a65, v255
    v_accvgpr_write_b32 a66, v1
    v_accvgpr_write_b32 a67, v5
    v_accvgpr_read_b32 v254, a68
    v_accvgpr_read_b32 v255, a69
    v_accvgpr_read_b32 v1, a70
    v_accvgpr_read_b32 v5, a71
    v_mul_f32 v254, v254, v250
    v_mul_f32 v255, v255, v250
    v_mul_f32 v1, v1, v250
    v_mul_f32 v5, v5, v250
    v_accvgpr_write_b32 a68, v254
    v_accvgpr_write_b32 a69, v255
    v_accvgpr_write_b32 a70, v1
    v_accvgpr_write_b32 a71, v5
    v_accvgpr_read_b32 v254, a72
    v_accvgpr_read_b32 v255, a73
    v_accvgpr_read_b32 v1, a74
    v_accvgpr_read_b32 v5, a75
    v_mul_f32 v254, v254, v248
    v_mul_f32 v255, v255, v248
    v_mul_f32 v1, v1, v248
    v_mul_f32 v5, v5, v248
    v_accvgpr_write_b32 a72, v254
    v_accvgpr_write_b32 a73, v255
    v_accvgpr_write_b32 a74, v1
    v_accvgpr_write_b32 a75, v5
    v_accvgpr_read_b32 v254, a76
    v_accvgpr_read_b32 v255, a77
    v_accvgpr_read_b32 v1, a78
    v_accvgpr_read_b32 v5, a79
    v_mul_f32 v254, v254, v249
    v_mul_f32 v255, v255, v249
    v_mul_f32 v1, v1, v249
    v_mul_f32 v5, v5, v249
    v_accvgpr_write_b32 a76, v254
    v_accvgpr_write_b32 a77, v255
    v_accvgpr_write_b32 a78, v1
    v_accvgpr_write_b32 a79, v5
    v_accvgpr_read_b32 v254, a80
    v_accvgpr_read_b32 v255, a81
    v_accvgpr_read_b32 v1, a82
    v_accvgpr_read_b32 v5, a83
    v_mul_f32 v254, v254, v250
    v_mul_f32 v255, v255, v250
    v_mul_f32 v1, v1, v250
    v_mul_f32 v5, v5, v250
    v_accvgpr_write_b32 a80, v254
    v_accvgpr_write_b32 a81, v255
    v_accvgpr_write_b32 a82, v1
    v_accvgpr_write_b32 a83, v5
    v_accvgpr_read_b32 v254, a84
    v_accvgpr_read_b32 v255, a85
    v_accvgpr_read_b32 v1, a86
    v_accvgpr_read_b32 v5, a87
    v_mul_f32 v254, v254, v248
    v_mul_f32 v255, v255, v248
    v_mul_f32 v1, v1, v248
    v_mul_f32 v5, v5, v248
    v_accvgpr_write_b32 a84, v254
    v_accvgpr_write_b32 a85, v255
    v_accvgpr_write_b32 a86, v1
    v_accvgpr_write_b32 a87, v5
    v_accvgpr_read_b32 v254, a88
    v_accvgpr_read_b32 v255, a89
    v_accvgpr_read_b32 v1, a90
    v_accvgpr_read_b32 v5, a91
    v_mul_f32 v254, v254, v249
    v_mul_f32 v255, v255, v249
    v_mul_f32 v1, v1, v249
    v_mul_f32 v5, v5, v249
    v_accvgpr_write_b32 a88, v254
    v_accvgpr_write_b32 a89, v255
    v_accvgpr_write_b32 a90, v1
    v_accvgpr_write_b32 a91, v5
    v_accvgpr_read_b32 v254, a92
    v_accvgpr_read_b32 v255, a93
    v_accvgpr_read_b32 v1, a94
    v_accvgpr_read_b32 v5, a95
    v_mul_f32 v254, v254, v250
    v_mul_f32 v255, v255, v250
    v_mul_f32 v1, v1, v250
    v_mul_f32 v5, v5, v250
    v_accvgpr_write_b32 a92, v254
    v_accvgpr_write_b32 a93, v255
    v_accvgpr_write_b32 a94, v1
    v_accvgpr_write_b32 a95, v5
    v_accvgpr_read_b32 v254, a96
    v_accvgpr_read_b32 v255, a97
    v_accvgpr_read_b32 v1, a98
    v_accvgpr_read_b32 v5, a99
    v_mul_f32 v254, v254, v248
    v_mul_f32 v255, v255, v248
    v_mul_f32 v1, v1, v248
    v_mul_f32 v5, v5, v248
    v_accvgpr_write_b32 a96, v254
    v_accvgpr_write_b32 a97, v255
    v_accvgpr_write_b32 a98, v1
    v_accvgpr_write_b32 a99, v5
    v_accvgpr_read_b32 v254, a100
    v_accvgpr_read_b32 v255, a101
    v_accvgpr_read_b32 v1, a102
    v_accvgpr_read_b32 v5, a103
    v_mul_f32 v254, v254, v249
    v_mul_f32 v255, v255, v249
    v_mul_f32 v1, v1, v249
    v_mul_f32 v5, v5, v249
    v_accvgpr_write_b32 a100, v254
    v_accvgpr_write_b32 a101, v255
    v_accvgpr_write_b32 a102, v1
    v_accvgpr_write_b32 a103, v5
    v_accvgpr_read_b32 v254, a104
    v_accvgpr_read_b32 v255, a105
    v_accvgpr_read_b32 v1, a106
    v_accvgpr_read_b32 v5, a107
    v_mul_f32 v254, v254, v250
    v_mul_f32 v255, v255, v250
    v_mul_f32 v1, v1, v250
    v_mul_f32 v5, v5, v250
    v_accvgpr_write_b32 a104, v254
    v_accvgpr_write_b32 a105, v255
    v_accvgpr_write_b32 a106, v1
    v_accvgpr_write_b32 a107, v5
    v_accvgpr_read_b32 v254, a108
    v_accvgpr_read_b32 v255, a109
    v_accvgpr_read_b32 v1, a110
    v_accvgpr_read_b32 v5, a111
    v_mul_f32 v254, v254, v248
    v_mul_f32 v255, v255, v248
    v_mul_f32 v1, v1, v248
    v_mul_f32 v5, v5, v248
    v_accvgpr_write_b32 a108, v254
    v_accvgpr_write_b32 a109, v255
    v_accvgpr_write_b32 a110, v1
    v_accvgpr_write_b32 a111, v5
    v_accvgpr_read_b32 v254, a112
    v_accvgpr_read_b32 v255, a113
    v_accvgpr_read_b32 v1, a114
    v_accvgpr_read_b32 v5, a115
    v_mul_f32 v254, v254, v249
    v_mul_f32 v255, v255, v249
    v_mul_f32 v1, v1, v249
    v_mul_f32 v5, v5, v249
    v_accvgpr_write_b32 a112, v254
    v_accvgpr_write_b32 a113, v255
    v_accvgpr_write_b32 a114, v1
    v_accvgpr_write_b32 a115, v5
    v_accvgpr_read_b32 v254, a116
    v_accvgpr_read_b32 v255, a117
    v_accvgpr_read_b32 v1, a118
    v_accvgpr_read_b32 v5, a119
    v_mul_f32 v254, v254, v250
    v_mul_f32 v255, v255, v250
    v_mul_f32 v1, v1, v250
    v_mul_f32 v5, v5, v250
    v_accvgpr_write_b32 a116, v254
    v_accvgpr_write_b32 a117, v255
    v_accvgpr_write_b32 a118, v1
    v_accvgpr_write_b32 a119, v5
    v_accvgpr_read_b32 v254, a120
    v_accvgpr_read_b32 v255, a121
    v_accvgpr_read_b32 v1, a122
    v_accvgpr_read_b32 v5, a123
    v_mul_f32 v254, v254, v248
    v_mul_f32 v255, v255, v248
    v_mul_f32 v1, v1, v248
    v_mul_f32 v5, v5, v248
    v_accvgpr_write_b32 a120, v254
    v_accvgpr_write_b32 a121, v255
    v_accvgpr_write_b32 a122, v1
    v_accvgpr_write_b32 a123, v5
    v_accvgpr_read_b32 v254, a124
    v_accvgpr_read_b32 v255, a125
    v_accvgpr_read_b32 v1, a126
    v_accvgpr_read_b32 v5, a127
    v_mul_f32 v254, v254, v249
    v_mul_f32 v255, v255, v249
    v_mul_f32 v1, v1, v249
    v_mul_f32 v5, v5, v249
    v_accvgpr_write_b32 a124, v254
    v_accvgpr_write_b32 a125, v255
    v_accvgpr_write_b32 a126, v1
    v_accvgpr_write_b32 a127, v5
    v_accvgpr_read_b32 v254, a128
    v_accvgpr_read_b32 v255, a129
    v_accvgpr_read_b32 v1, a130
    v_accvgpr_read_b32 v5, a131
    v_mul_f32 v254, v254, v250
    v_mul_f32 v255, v255, v250
    v_mul_f32 v1, v1, v250
    v_mul_f32 v5, v5, v250
    v_accvgpr_write_b32 a128, v254
    v_accvgpr_write_b32 a129, v255
    v_accvgpr_write_b32 a130, v1
    v_accvgpr_write_b32 a131, v5
    v_accvgpr_read_b32 v254, a132
    v_accvgpr_read_b32 v255, a133
    v_accvgpr_read_b32 v1, a134
    v_accvgpr_read_b32 v5, a135
    v_mul_f32 v254, v254, v248
    v_mul_f32 v255, v255, v248
    v_mul_f32 v1, v1, v248
    v_mul_f32 v5, v5, v248
    v_accvgpr_write_b32 a132, v254
    v_accvgpr_write_b32 a133, v255
    v_accvgpr_write_b32 a134, v1
    v_accvgpr_write_b32 a135, v5
    v_accvgpr_read_b32 v254, a136
    v_accvgpr_read_b32 v255, a137
    v_accvgpr_read_b32 v1, a138
    v_accvgpr_read_b32 v5, a139
    v_mul_f32 v254, v254, v249
    v_mul_f32 v255, v255, v249
    v_mul_f32 v1, v1, v249
    v_mul_f32 v5, v5, v249
    v_accvgpr_write_b32 a136, v254
    v_accvgpr_write_b32 a137, v255
    v_accvgpr_write_b32 a138, v1
    v_accvgpr_write_b32 a139, v5
    v_accvgpr_read_b32 v254, a140
    v_accvgpr_read_b32 v255, a141
    v_accvgpr_read_b32 v1, a142
    v_accvgpr_read_b32 v5, a143
    v_mul_f32 v254, v254, v250
    v_mul_f32 v255, v255, v250
    v_mul_f32 v1, v1, v250
    v_mul_f32 v5, v5, v250
    v_accvgpr_write_b32 a140, v254
    v_accvgpr_write_b32 a141, v255
    v_accvgpr_write_b32 a142, v1
    v_accvgpr_write_b32 a143, v5
    v_accvgpr_read_b32 v254, a144
    v_accvgpr_read_b32 v255, a145
    v_accvgpr_read_b32 v1, a146
    v_accvgpr_read_b32 v5, a147
    v_mul_f32 v254, v254, v248
    v_mul_f32 v255, v255, v248
    v_mul_f32 v1, v1, v248
    v_mul_f32 v5, v5, v248
    v_accvgpr_write_b32 a144, v254
    v_accvgpr_write_b32 a145, v255
    v_accvgpr_write_b32 a146, v1
    v_accvgpr_write_b32 a147, v5
    v_accvgpr_read_b32 v254, a148
    v_accvgpr_read_b32 v255, a149
    v_accvgpr_read_b32 v1, a150
    v_accvgpr_read_b32 v5, a151
    v_mul_f32 v254, v254, v249
    v_mul_f32 v255, v255, v249
    v_mul_f32 v1, v1, v249
    v_mul_f32 v5, v5, v249
    v_accvgpr_write_b32 a148, v254
    v_accvgpr_write_b32 a149, v255
    v_accvgpr_write_b32 a150, v1
    v_accvgpr_write_b32 a151, v5
    v_accvgpr_read_b32 v254, a152
    v_accvgpr_read_b32 v255, a153
    v_accvgpr_read_b32 v1, a154
    v_accvgpr_read_b32 v5, a155
    v_mul_f32 v254, v254, v250
    v_mul_f32 v255, v255, v250
    v_mul_f32 v1, v1, v250
    v_mul_f32 v5, v5, v250
    v_accvgpr_write_b32 a152, v254
    v_accvgpr_write_b32 a153, v255
    v_accvgpr_write_b32 a154, v1
    v_accvgpr_write_b32 a155, v5
    v_accvgpr_read_b32 v254, a156
    v_accvgpr_read_b32 v255, a157
    v_accvgpr_read_b32 v1, a158
    v_accvgpr_read_b32 v5, a159
    v_mul_f32 v254, v254, v248
    v_mul_f32 v255, v255, v248
    v_mul_f32 v1, v1, v248
    v_mul_f32 v5, v5, v248
    v_accvgpr_write_b32 a156, v254
    v_accvgpr_write_b32 a157, v255
    v_accvgpr_write_b32 a158, v1
    v_accvgpr_write_b32 a159, v5
    v_accvgpr_read_b32 v254, a160
    v_accvgpr_read_b32 v255, a161
    v_accvgpr_read_b32 v1, a162
    v_accvgpr_read_b32 v5, a163
    v_mul_f32 v254, v254, v249
    v_mul_f32 v255, v255, v249
    v_mul_f32 v1, v1, v249
    v_mul_f32 v5, v5, v249
    v_accvgpr_write_b32 a160, v254
    v_accvgpr_write_b32 a161, v255
    v_accvgpr_write_b32 a162, v1
    v_accvgpr_write_b32 a163, v5
    v_accvgpr_read_b32 v254, a164
    v_accvgpr_read_b32 v255, a165
    v_accvgpr_read_b32 v1, a166
    v_accvgpr_read_b32 v5, a167
    v_mul_f32 v254, v254, v250
    v_mul_f32 v255, v255, v250
    v_mul_f32 v1, v1, v250
    v_mul_f32 v5, v5, v250
    v_accvgpr_write_b32 a164, v254
    v_accvgpr_write_b32 a165, v255
    v_accvgpr_write_b32 a166, v1
    v_accvgpr_write_b32 a167, v5
    v_accvgpr_read_b32 v254, a168
    v_accvgpr_read_b32 v255, a169
    v_accvgpr_read_b32 v1, a170
    v_accvgpr_read_b32 v5, a171
    v_mul_f32 v254, v254, v248
    v_mul_f32 v255, v255, v248
    v_mul_f32 v1, v1, v248
    v_mul_f32 v5, v5, v248
    v_accvgpr_write_b32 a168, v254
    v_accvgpr_write_b32 a169, v255
    v_accvgpr_write_b32 a170, v1
    v_accvgpr_write_b32 a171, v5
    v_accvgpr_read_b32 v254, a172
    v_accvgpr_read_b32 v255, a173
    v_accvgpr_read_b32 v1, a174
    v_accvgpr_read_b32 v5, a175
    v_mul_f32 v254, v254, v249
    v_mul_f32 v255, v255, v249
    v_mul_f32 v1, v1, v249
    v_mul_f32 v5, v5, v249
    v_accvgpr_write_b32 a172, v254
    v_accvgpr_write_b32 a173, v255
    v_accvgpr_write_b32 a174, v1
    v_accvgpr_write_b32 a175, v5
    v_accvgpr_read_b32 v254, a176
    v_accvgpr_read_b32 v255, a177
    v_accvgpr_read_b32 v1, a178
    v_accvgpr_read_b32 v5, a179
    v_mul_f32 v254, v254, v250
    v_mul_f32 v255, v255, v250
    v_mul_f32 v1, v1, v250
    v_mul_f32 v5, v5, v250
    v_accvgpr_write_b32 a176, v254
    v_accvgpr_write_b32 a177, v255
    v_accvgpr_write_b32 a178, v1
    v_accvgpr_write_b32 a179, v5
    v_accvgpr_read_b32 v254, a180
    v_accvgpr_read_b32 v255, a181
    v_accvgpr_read_b32 v1, a182
    v_accvgpr_read_b32 v5, a183
    v_mul_f32 v254, v254, v248
    v_mul_f32 v255, v255, v248
    v_mul_f32 v1, v1, v248
    v_mul_f32 v5, v5, v248
    v_accvgpr_write_b32 a180, v254
    v_accvgpr_write_b32 a181, v255
    v_accvgpr_write_b32 a182, v1
    v_accvgpr_write_b32 a183, v5
    v_accvgpr_read_b32 v254, a184
    v_accvgpr_read_b32 v255, a185
    v_accvgpr_read_b32 v1, a186
    v_accvgpr_read_b32 v5, a187
    v_mul_f32 v254, v254, v249
    v_mul_f32 v255, v255, v249
    v_mul_f32 v1, v1, v249
    v_mul_f32 v5, v5, v249
    v_accvgpr_write_b32 a184, v254
    v_accvgpr_write_b32 a185, v255
    v_accvgpr_write_b32 a186, v1
    v_accvgpr_write_b32 a187, v5
    v_accvgpr_read_b32 v254, a188
    v_accvgpr_read_b32 v255, a189
    v_accvgpr_read_b32 v1, a190
    v_accvgpr_read_b32 v5, a191
    v_mul_f32 v254, v254, v250
    v_mul_f32 v255, v255, v250
    v_mul_f32 v1, v1, v250
    v_mul_f32 v5, v5, v250
    v_accvgpr_write_b32 a188, v254
    v_accvgpr_write_b32 a189, v255
    v_accvgpr_write_b32 a190, v1
    v_accvgpr_write_b32 a191, v5
    v_fma_f32 v248, v8, s24, v236
    v_fma_f32 v249, v9, s24, v236
    v_fma_f32 v250, v10, s24, v236
    v_fma_f32 v251, v11, s24, v236
    v_exp_f32 v248, v248
    v_exp_f32 v249, v249
    v_fma_f32 v252, v12, s24, v237
    v_fma_f32 v253, v13, s24, v237
    v_exp_f32 v250, v250
    v_exp_f32 v251, v251
    v_add_f32 v242, v248, v249
    v_cvt_pk_bf16_f32 v104, v248, v249
    v_fma_f32 v248, v14, s24, v237
    v_fma_f32 v249, v15, s24, v237
    v_exp_f32 v252, v252
    v_exp_f32 v253, v253
    v_add_f32 v242, v242, v250
    v_add_f32 v242, v242, v251
    v_cvt_pk_bf16_f32 v105, v250, v251
    v_fma_f32 v250, v16, s24, v238
    v_fma_f32 v251, v17, s24, v238
    v_exp_f32 v248, v248
    v_exp_f32 v249, v249
    v_add_f32 v243, v252, v253
    v_cvt_pk_bf16_f32 v108, v252, v253
    v_fma_f32 v252, v18, s24, v238
    v_fma_f32 v253, v19, s24, v238
    v_exp_f32 v250, v250
    v_exp_f32 v251, v251
    v_add_f32 v243, v243, v248
    v_add_f32 v243, v243, v249
    v_cvt_pk_bf16_f32 v109, v248, v249
    v_fma_f32 v248, v20, s24, v236
    v_fma_f32 v249, v21, s24, v236
    v_exp_f32 v252, v252
    v_exp_f32 v253, v253
    v_add_f32 v244, v250, v251
    v_cvt_pk_bf16_f32 v112, v250, v251
    v_fma_f32 v250, v22, s24, v236
    v_fma_f32 v251, v23, s24, v236
    v_exp_f32 v248, v248
    v_exp_f32 v249, v249
    v_add_f32 v244, v244, v252
    v_add_f32 v244, v244, v253
    v_cvt_pk_bf16_f32 v113, v252, v253
    v_fma_f32 v252, v24, s24, v237
    v_fma_f32 v253, v25, s24, v237
    v_exp_f32 v250, v250
    v_exp_f32 v251, v251
    v_add_f32 v242, v242, v248
    v_add_f32 v242, v242, v249
    v_cvt_pk_bf16_f32 v106, v248, v249
    v_fma_f32 v248, v26, s24, v237
    v_fma_f32 v249, v27, s24, v237
    v_exp_f32 v252, v252
    v_exp_f32 v253, v253
    v_add_f32 v242, v242, v250
    v_add_f32 v242, v242, v251
    v_cvt_pk_bf16_f32 v107, v250, v251
    v_fma_f32 v250, v28, s24, v238
    v_fma_f32 v251, v29, s24, v238
    v_exp_f32 v248, v248
    v_exp_f32 v249, v249
    v_add_f32 v243, v243, v252
    v_add_f32 v243, v243, v253
    v_cvt_pk_bf16_f32 v110, v252, v253
    v_fma_f32 v252, v30, s24, v238
    v_fma_f32 v253, v31, s24, v238
    v_exp_f32 v250, v250
    v_exp_f32 v251, v251
    v_add_f32 v243, v243, v248
    v_add_f32 v243, v243, v249
    v_cvt_pk_bf16_f32 v111, v248, v249
    v_exp_f32 v252, v252
    v_exp_f32 v253, v253
    v_add_f32 v244, v244, v250
    v_add_f32 v244, v244, v251
    v_cvt_pk_bf16_f32 v114, v250, v251
    v_add_f32 v244, v244, v252
    v_add_f32 v244, v244, v253
    v_cvt_pk_bf16_f32 v115, v252, v253
    v_fma_f32 v248, v32, s24, v236
    v_fma_f32 v249, v33, s24, v236
    v_fma_f32 v250, v34, s24, v236
    v_fma_f32 v251, v35, s24, v236
    v_exp_f32 v248, v248
    v_exp_f32 v249, v249
    v_fma_f32 v252, v36, s24, v237
    v_fma_f32 v253, v37, s24, v237
    v_exp_f32 v250, v250
    v_exp_f32 v251, v251
    v_add_f32 v245, v248, v249
    v_cvt_pk_bf16_f32 v116, v248, v249
    v_fma_f32 v248, v38, s24, v237
    v_fma_f32 v249, v39, s24, v237
    v_exp_f32 v252, v252
    v_exp_f32 v253, v253
    v_add_f32 v245, v245, v250
    v_add_f32 v245, v245, v251
    v_cvt_pk_bf16_f32 v117, v250, v251
    v_fma_f32 v250, v40, s24, v238
    v_fma_f32 v251, v41, s24, v238
    v_exp_f32 v248, v248
    v_exp_f32 v249, v249
    v_add_f32 v246, v252, v253
    v_cvt_pk_bf16_f32 v120, v252, v253
    v_fma_f32 v252, v42, s24, v238
    v_fma_f32 v253, v43, s24, v238
    v_exp_f32 v250, v250
    v_exp_f32 v251, v251
    v_add_f32 v246, v246, v248
    v_add_f32 v246, v246, v249
    v_cvt_pk_bf16_f32 v121, v248, v249
    v_fma_f32 v248, v44, s24, v236
    v_fma_f32 v249, v45, s24, v236
    v_exp_f32 v252, v252
    v_exp_f32 v253, v253
    v_add_f32 v247, v250, v251
    v_cvt_pk_bf16_f32 v124, v250, v251
    v_fma_f32 v250, v46, s24, v236
    v_fma_f32 v251, v47, s24, v236
    v_exp_f32 v248, v248
    v_exp_f32 v249, v249
    v_add_f32 v247, v247, v252
    v_add_f32 v247, v247, v253
    v_cvt_pk_bf16_f32 v125, v252, v253
    v_fma_f32 v252, v48, s24, v237
    v_fma_f32 v253, v49, s24, v237
    v_exp_f32 v250, v250
    v_exp_f32 v251, v251
    v_add_f32 v245, v245, v248
    v_add_f32 v245, v245, v249
    v_cvt_pk_bf16_f32 v118, v248, v249
    v_fma_f32 v248, v50, s24, v237
    v_fma_f32 v249, v51, s24, v237
    v_exp_f32 v252, v252
    v_exp_f32 v253, v253
    v_add_f32 v245, v245, v250
    v_add_f32 v245, v245, v251
    v_cvt_pk_bf16_f32 v119, v250, v251
    v_fma_f32 v250, v52, s24, v238
    v_fma_f32 v251, v53, s24, v238
    v_exp_f32 v248, v248
    v_exp_f32 v249, v249
    v_add_f32 v246, v246, v252
    v_add_f32 v246, v246, v253
    v_cvt_pk_bf16_f32 v122, v252, v253
    v_fma_f32 v252, v54, s24, v238
    v_fma_f32 v253, v55, s24, v238
    v_exp_f32 v250, v250
    v_exp_f32 v251, v251
    v_add_f32 v246, v246, v248
    v_add_f32 v246, v246, v249
    v_cvt_pk_bf16_f32 v123, v248, v249
    v_exp_f32 v252, v252
    v_exp_f32 v253, v253
    v_add_f32 v247, v247, v250
    v_add_f32 v247, v247, v251
    v_cvt_pk_bf16_f32 v126, v250, v251
    v_add_f32 v247, v247, v252
    v_add_f32 v247, v247, v253
    v_cvt_pk_bf16_f32 v127, v252, v253
    v_add_f32 v254, v242, v245
    v_add_f32 v255, v243, v246
    v_add_f32 v1, v244, v247
    s_branch L_back_l0
L_slow_l1:
    v_max3_f32 v254, v56, v57, v58
    v_max3_f32 v254, v254, v59, v68
    v_max3_f32 v254, v254, v69, v70
    v_max3_f32 v254, v254, v71, v80
    v_max3_f32 v254, v254, v81, v82
    v_max3_f32 v254, v254, v83, v92
    v_max3_f32 v254, v254, v93, v94
    v_max_f32 v254, v254, v95
    v_mov_b32 v255, v254
    s_nop 1
    v_permlane32_swap_b32 v254, v255
    v_max_f32 v254, v254, v255
    v_mov_b32 v255, v254
    s_nop 1
    v_permlane16_swap_b32 v254, v255
    v_max_f32 v254, v254, v255
    v_max_f32 v254, v254, v2
    v_sub_f32 v255, v2, v254
    v_mul_f32 v255, s24, v255
    v_exp_f32 v248, v255
    v_mov_b32 v2, v254
    v_mul_f32 v236, -v254, s24
    v_mul_f32 v239, v239, v248
    v_max3_f32 v254, v60, v61, v62
    v_max3_f32 v254, v254, v63, v72
    v_max3_f32 v254, v254, v73, v74
    v_max3_f32 v254, v254, v75, v84
    v_max3_f32 v254, v254, v85, v86
    v_max3_f32 v254, v254, v87, v96
    v_max3_f32 v254, v254, v97, v98
    v_max_f32 v254, v254, v99
    v_mov_b32 v255, v254
    s_nop 1
    v_permlane32_swap_b32 v254, v255
    v_max_f32 v254, v254, v255
    v_mov_b32 v255, v254
    s_nop 1
    v_permlane16_swap_b32 v254, v255
    v_max_f32 v254, v254, v255
    v_max_f32 v254, v254, v3
    v_sub_f32 v255, v3, v254
    v_mul_f32 v255, s24, v255
    v_exp_f32 v249, v255
    v_mov_b32 v3, v254
    v_mul_f32 v237, -v254, s24
    v_mul_f32 v240, v240, v249
    v_max3_f32 v254, v64, v65, v66
    v_max3_f32 v254, v254, v67, v76
    v_max3_f32 v254, v254, v77, v78
    v_max3_f32 v254, v254, v79, v88
    v_max3_f32 v254, v254, v89, v90
    v_max3_f32 v254, v254, v91, v100
    v_max3_f32 v254, v254, v101, v102
    v_max_f32 v254, v254, v103
    v_mov_b32 v255, v254
    s_nop 1
    v_permlane32_swap_b32 v254, v255
    v_max_f32 v254, v254, v255
    v_mov_b32 v255, v254
    s_nop 1
    v_permlane16_swap_b32 v254, v255
    v_max_f32 v254, v254, v255
    v_max_f32 v254, v254, v4
    v_sub_f32 v255, v4, v254
    v_mul_f32 v255, s24, v255
    v_exp_f32 v250, v255
    v_mov_b32 v4, v254
    v_mul_f32 v238, -v254, s24
    v_mul_f32 v241, v241, v250
    v_accvgpr_read_b32 v254, a0
    v_accvgpr_read_b32 v255, a1
    v_accvgpr_read_b32 v1, a2
    v_accvgpr_read_b32 v5, a3
    v_mul_f32 v254, v254, v248
    v_mul_f32 v255, v255, v248
    v_mul_f32 v1, v1, v248
    v_mul_f32 v5, v5, v248
    v_accvgpr_write_b32 a0, v254
    v_accvgpr_write_b32 a1, v255
    v_accvgpr_write_b32 a2, v1
    v_accvgpr_write_b32 a3, v5
    v_accvgpr_read_b32 v254, a4
    v_accvgpr_read_b32 v255, a5
    v_accvgpr_read_b32 v1, a6
    v_accvgpr_read_b32 v5, a7
    v_mul_f32 v254, v254, v249
    v_mul_f32 v255, v255, v249
    v_mul_f32 v1, v1, v249
    v_mul_f32 v5, v5, v249
    v_accvgpr_write_b32 a4, v254
    v_accvgpr_write_b32 a5, v255
    v_accvgpr_write_b32 a6, v1
    v_accvgpr_write_b32 a7, v5
    v_accvgpr_read_b32 v254, a8
    v_accvgpr_read_b32 v255, a9
    v_accvgpr_read_b32 v1, a10
    v_accvgpr_read_b32 v5, a11
    v_mul_f32 v254, v254, v250
    v_mul_f32 v255, v255, v250
    v_mul_f32 v1, v1, v250
    v_mul_f32 v5, v5, v250
    v_accvgpr_write_b32 a8, v254
    v_accvgpr_write_b32 a9, v255
    v_accvgpr_write_b32 a10, v1
    v_accvgpr_write_b32 a11, v5
    v_accvgpr_read_b32 v254, a12
    v_accvgpr_read_b32 v255, a13
    v_accvgpr_read_b32 v1, a14
    v_accvgpr_read_b32 v5, a15
    v_mul_f32 v254, v254, v248
    v_mul_f32 v255, v255, v248
    v_mul_f32 v1, v1, v248
    v_mul_f32 v5, v5, v248
    v_accvgpr_write_b32 a12, v254
    v_accvgpr_write_b32 a13, v255
    v_accvgpr_write_b32 a14, v1
    v_accvgpr_write_b32 a15, v5
    v_accvgpr_read_b32 v254, a16
    v_accvgpr_read_b32 v255, a17
    v_accvgpr_read_b32 v1, a18
    v_accvgpr_read_b32 v5, a19
    v_mul_f32 v254, v254, v249
    v_mul_f32 v255, v255, v249
    v_mul_f32 v1, v1, v249
    v_mul_f32 v5, v5, v249
    v_accvgpr_write_b32 a16, v254
    v_accvgpr_write_b32 a17, v255
    v_accvgpr_write_b32 a18, v1
    v_accvgpr_write_b32 a19, v5
    v_accvgpr_read_b32 v254, a20
    v_accvgpr_read_b32 v255, a21
    v_accvgpr_read_b32 v1, a22
    v_accvgpr_read_b32 v5, a23
    v_mul_f32 v254, v254, v250
    v_mul_f32 v255, v255, v250
    v_mul_f32 v1, v1, v250
    v_mul_f32 v5, v5, v250
    v_accvgpr_write_b32 a20, v254
    v_accvgpr_write_b32 a21, v255
    v_accvgpr_write_b32 a22, v1
    v_accvgpr_write_b32 a23, v5
    v_accvgpr_read_b32 v254, a24
    v_accvgpr_read_b32 v255, a25
    v_accvgpr_read_b32 v1, a26
    v_accvgpr_read_b32 v5, a27
    v_mul_f32 v254, v254, v248
    v_mul_f32 v255, v255, v248
    v_mul_f32 v1, v1, v248
    v_mul_f32 v5, v5, v248
    v_accvgpr_write_b32 a24, v254
    v_accvgpr_write_b32 a25, v255
    v_accvgpr_write_b32 a26, v1
    v_accvgpr_write_b32 a27, v5
    v_accvgpr_read_b32 v254, a28
    v_accvgpr_read_b32 v255, a29
    v_accvgpr_read_b32 v1, a30
    v_accvgpr_read_b32 v5, a31
    v_mul_f32 v254, v254, v249
    v_mul_f32 v255, v255, v249
    v_mul_f32 v1, v1, v249
    v_mul_f32 v5, v5, v249
    v_accvgpr_write_b32 a28, v254
    v_accvgpr_write_b32 a29, v255
    v_accvgpr_write_b32 a30, v1
    v_accvgpr_write_b32 a31, v5
    v_accvgpr_read_b32 v254, a32
    v_accvgpr_read_b32 v255, a33
    v_accvgpr_read_b32 v1, a34
    v_accvgpr_read_b32 v5, a35
    v_mul_f32 v254, v254, v250
    v_mul_f32 v255, v255, v250
    v_mul_f32 v1, v1, v250
    v_mul_f32 v5, v5, v250
    v_accvgpr_write_b32 a32, v254
    v_accvgpr_write_b32 a33, v255
    v_accvgpr_write_b32 a34, v1
    v_accvgpr_write_b32 a35, v5
    v_accvgpr_read_b32 v254, a36
    v_accvgpr_read_b32 v255, a37
    v_accvgpr_read_b32 v1, a38
    v_accvgpr_read_b32 v5, a39
    v_mul_f32 v254, v254, v248
    v_mul_f32 v255, v255, v248
    v_mul_f32 v1, v1, v248
    v_mul_f32 v5, v5, v248
    v_accvgpr_write_b32 a36, v254
    v_accvgpr_write_b32 a37, v255
    v_accvgpr_write_b32 a38, v1
    v_accvgpr_write_b32 a39, v5
    v_accvgpr_read_b32 v254, a40
    v_accvgpr_read_b32 v255, a41
    v_accvgpr_read_b32 v1, a42
    v_accvgpr_read_b32 v5, a43
    v_mul_f32 v254, v254, v249
    v_mul_f32 v255, v255, v249
    v_mul_f32 v1, v1, v249
    v_mul_f32 v5, v5, v249
    v_accvgpr_write_b32 a40, v254
    v_accvgpr_write_b32 a41, v255
    v_accvgpr_write_b32 a42, v1
    v_accvgpr_write_b32 a43, v5
    v_accvgpr_read_b32 v254, a44
    v_accvgpr_read_b32 v255, a45
    v_accvgpr_read_b32 v1, a46
    v_accvgpr_read_b32 v5, a47
    v_mul_f32 v254, v254, v250
    v_mul_f32 v255, v255, v250
    v_mul_f32 v1, v1, v250
    v_mul_f32 v5, v5, v250
    v_accvgpr_write_b32 a44, v254
    v_accvgpr_write_b32 a45, v255
    v_accvgpr_write_b32 a46, v1
    v_accvgpr_write_b32 a47, v5
    v_accvgpr_read_b32 v254, a48
    v_accvgpr_read_b32 v255, a49
    v_accvgpr_read_b32 v1, a50
    v_accvgpr_read_b32 v5, a51
    v_mul_f32 v254, v254, v248
    v_mul_f32 v255, v255, v248
    v_mul_f32 v1, v1, v248
    v_mul_f32 v5, v5, v248
    v_accvgpr_write_b32 a48, v254
    v_accvgpr_write_b32 a49, v255
    v_accvgpr_write_b32 a50, v1
    v_accvgpr_write_b32 a51, v5
    v_accvgpr_read_b32 v254, a52
    v_accvgpr_read_b32 v255, a53
    v_accvgpr_read_b32 v1, a54
    v_accvgpr_read_b32 v5, a55
    v_mul_f32 v254, v254, v249
    v_mul_f32 v255, v255, v249
    v_mul_f32 v1, v1, v249
    v_mul_f32 v5, v5, v249
    v_accvgpr_write_b32 a52, v254
    v_accvgpr_write_b32 a53, v255
    v_accvgpr_write_b32 a54, v1
    v_accvgpr_write_b32 a55, v5
    v_accvgpr_read_b32 v254, a56
    v_accvgpr_read_b32 v255, a57
    v_accvgpr_read_b32 v1, a58
    v_accvgpr_read_b32 v5, a59
    v_mul_f32 v254, v254, v250
    v_mul_f32 v255, v255, v250
    v_mul_f32 v1, v1, v250
    v_mul_f32 v5, v5, v250
    v_accvgpr_write_b32 a56, v254
    v_accvgpr_write_b32 a57, v255
    v_accvgpr_write_b32 a58, v1
    v_accvgpr_write_b32 a59, v5
    v_accvgpr_read_b32 v254, a60
    v_accvgpr_read_b32 v255, a61
    v_accvgpr_read_b32 v1, a62
    v_accvgpr_read_b32 v5, a63
    v_mul_f32 v254, v254, v248
    v_mul_f32 v255, v255, v248
    v_mul_f32 v1, v1, v248
    v_mul_f32 v5, v5, v248
    v_accvgpr_write_b32 a60, v254
    v_accvgpr_write_b32 a61, v255
    v_accvgpr_write_b32 a62, v1
    v_accvgpr_write_b32 a63, v5
    v_accvgpr_read_b32 v254, a64
    v_accvgpr_read_b32 v255, a65
    v_accvgpr_read_b32 v1, a66
    v_accvgpr_read_b32 v5, a67
    v_mul_f32 v254, v254, v249
    v_mul_f32 v255, v255, v249
    v_mul_f32 v1, v1, v249
    v_mul_f32 v5, v5, v249
    v_accvgpr_write_b32 a64, v254
    v_accvgpr_write_b32 a65, v255
    v_accvgpr_write_b32 a66, v1
    v_accvgpr_write_b32 a67, v5
    v_accvgpr_read_b32 v254, a68
    v_accvgpr_read_b32 v255, a69
    v_accvgpr_read_b32 v1, a70
    v_accvgpr_read_b32 v5, a71
    v_mul_f32 v254, v254, v250
    v_mul_f32 v255, v255, v250
    v_mul_f32 v1, v1, v250
    v_mul_f32 v5, v5, v250
    v_accvgpr_write_b32 a68, v254
    v_accvgpr_write_b32 a69, v255
    v_accvgpr_write_b32 a70, v1
    v_accvgpr_write_b32 a71, v5
    v_accvgpr_read_b32 v254, a72
    v_accvgpr_read_b32 v255, a73
    v_accvgpr_read_b32 v1, a74
    v_accvgpr_read_b32 v5, a75
    v_mul_f32 v254, v254, v248
    v_mul_f32 v255, v255, v248
    v_mul_f32 v1, v1, v248
    v_mul_f32 v5, v5, v248
    v_accvgpr_write_b32 a72, v254
    v_accvgpr_write_b32 a73, v255
    v_accvgpr_write_b32 a74, v1
    v_accvgpr_write_b32 a75, v5
    v_accvgpr_read_b32 v254, a76
    v_accvgpr_read_b32 v255, a77
    v_accvgpr_read_b32 v1, a78
    v_accvgpr_read_b32 v5, a79
    v_mul_f32 v254, v254, v249
    v_mul_f32 v255, v255, v249
    v_mul_f32 v1, v1, v249
    v_mul_f32 v5, v5, v249
    v_accvgpr_write_b32 a76, v254
    v_accvgpr_write_b32 a77, v255
    v_accvgpr_write_b32 a78, v1
    v_accvgpr_write_b32 a79, v5
    v_accvgpr_read_b32 v254, a80
    v_accvgpr_read_b32 v255, a81
    v_accvgpr_read_b32 v1, a82
    v_accvgpr_read_b32 v5, a83
    v_mul_f32 v254, v254, v250
    v_mul_f32 v255, v255, v250
    v_mul_f32 v1, v1, v250
    v_mul_f32 v5, v5, v250
    v_accvgpr_write_b32 a80, v254
    v_accvgpr_write_b32 a81, v255
    v_accvgpr_write_b32 a82, v1
    v_accvgpr_write_b32 a83, v5
    v_accvgpr_read_b32 v254, a84
    v_accvgpr_read_b32 v255, a85
    v_accvgpr_read_b32 v1, a86
    v_accvgpr_read_b32 v5, a87
    v_mul_f32 v254, v254, v248
    v_mul_f32 v255, v255, v248
    v_mul_f32 v1, v1, v248
    v_mul_f32 v5, v5, v248
    v_accvgpr_write_b32 a84, v254
    v_accvgpr_write_b32 a85, v255
    v_accvgpr_write_b32 a86, v1
    v_accvgpr_write_b32 a87, v5
    v_accvgpr_read_b32 v254, a88
    v_accvgpr_read_b32 v255, a89
    v_accvgpr_read_b32 v1, a90
    v_accvgpr_read_b32 v5, a91
    v_mul_f32 v254, v254, v249
    v_mul_f32 v255, v255, v249
    v_mul_f32 v1, v1, v249
    v_mul_f32 v5, v5, v249
    v_accvgpr_write_b32 a88, v254
    v_accvgpr_write_b32 a89, v255
    v_accvgpr_write_b32 a90, v1
    v_accvgpr_write_b32 a91, v5
    v_accvgpr_read_b32 v254, a92
    v_accvgpr_read_b32 v255, a93
    v_accvgpr_read_b32 v1, a94
    v_accvgpr_read_b32 v5, a95
    v_mul_f32 v254, v254, v250
    v_mul_f32 v255, v255, v250
    v_mul_f32 v1, v1, v250
    v_mul_f32 v5, v5, v250
    v_accvgpr_write_b32 a92, v254
    v_accvgpr_write_b32 a93, v255
    v_accvgpr_write_b32 a94, v1
    v_accvgpr_write_b32 a95, v5
    v_accvgpr_read_b32 v254, a96
    v_accvgpr_read_b32 v255, a97
    v_accvgpr_read_b32 v1, a98
    v_accvgpr_read_b32 v5, a99
    v_mul_f32 v254, v254, v248
    v_mul_f32 v255, v255, v248
    v_mul_f32 v1, v1, v248
    v_mul_f32 v5, v5, v248
    v_accvgpr_write_b32 a96, v254
    v_accvgpr_write_b32 a97, v255
    v_accvgpr_write_b32 a98, v1
    v_accvgpr_write_b32 a99, v5
    v_accvgpr_read_b32 v254, a100
    v_accvgpr_read_b32 v255, a101
    v_accvgpr_read_b32 v1, a102
    v_accvgpr_read_b32 v5, a103
    v_mul_f32 v254, v254, v249
    v_mul_f32 v255, v255, v249
    v_mul_f32 v1, v1, v249
    v_mul_f32 v5, v5, v249
    v_accvgpr_write_b32 a100, v254
    v_accvgpr_write_b32 a101, v255
    v_accvgpr_write_b32 a102, v1
    v_accvgpr_write_b32 a103, v5
    v_accvgpr_read_b32 v254, a104
    v_accvgpr_read_b32 v255, a105
    v_accvgpr_read_b32 v1, a106
    v_accvgpr_read_b32 v5, a107
    v_mul_f32 v254, v254, v250
    v_mul_f32 v255, v255, v250
    v_mul_f32 v1, v1, v250
    v_mul_f32 v5, v5, v250
    v_accvgpr_write_b32 a104, v254
    v_accvgpr_write_b32 a105, v255
    v_accvgpr_write_b32 a106, v1
    v_accvgpr_write_b32 a107, v5
    v_accvgpr_read_b32 v254, a108
    v_accvgpr_read_b32 v255, a109
    v_accvgpr_read_b32 v1, a110
    v_accvgpr_read_b32 v5, a111
    v_mul_f32 v254, v254, v248
    v_mul_f32 v255, v255, v248
    v_mul_f32 v1, v1, v248
    v_mul_f32 v5, v5, v248
    v_accvgpr_write_b32 a108, v254
    v_accvgpr_write_b32 a109, v255
    v_accvgpr_write_b32 a110, v1
    v_accvgpr_write_b32 a111, v5
    v_accvgpr_read_b32 v254, a112
    v_accvgpr_read_b32 v255, a113
    v_accvgpr_read_b32 v1, a114
    v_accvgpr_read_b32 v5, a115
    v_mul_f32 v254, v254, v249
    v_mul_f32 v255, v255, v249
    v_mul_f32 v1, v1, v249
    v_mul_f32 v5, v5, v249
    v_accvgpr_write_b32 a112, v254
    v_accvgpr_write_b32 a113, v255
    v_accvgpr_write_b32 a114, v1
    v_accvgpr_write_b32 a115, v5
    v_accvgpr_read_b32 v254, a116
    v_accvgpr_read_b32 v255, a117
    v_accvgpr_read_b32 v1, a118
    v_accvgpr_read_b32 v5, a119
    v_mul_f32 v254, v254, v250
    v_mul_f32 v255, v255, v250
    v_mul_f32 v1, v1, v250
    v_mul_f32 v5, v5, v250
    v_accvgpr_write_b32 a116, v254
    v_accvgpr_write_b32 a117, v255
    v_accvgpr_write_b32 a118, v1
    v_accvgpr_write_b32 a119, v5
    v_accvgpr_read_b32 v254, a120
    v_accvgpr_read_b32 v255, a121
    v_accvgpr_read_b32 v1, a122
    v_accvgpr_read_b32 v5, a123
    v_mul_f32 v254, v254, v248
    v_mul_f32 v255, v255, v248
    v_mul_f32 v1, v1, v248
    v_mul_f32 v5, v5, v248
    v_accvgpr_write_b32 a120, v254
    v_accvgpr_write_b32 a121, v255
    v_accvgpr_write_b32 a122, v1
    v_accvgpr_write_b32 a123, v5
    v_accvgpr_read_b32 v254, a124
    v_accvgpr_read_b32 v255, a125
    v_accvgpr_read_b32 v1, a126
    v_accvgpr_read_b32 v5, a127
    v_mul_f32 v254, v254, v249
    v_mul_f32 v255, v255, v249
    v_mul_f32 v1, v1, v249
    v_mul_f32 v5, v5, v249
    v_accvgpr_write_b32 a124, v254
    v_accvgpr_write_b32 a125, v255
    v_accvgpr_write_b32 a126, v1
    v_accvgpr_write_b32 a127, v5
    v_accvgpr_read_b32 v254, a128
    v_accvgpr_read_b32 v255, a129
    v_accvgpr_read_b32 v1, a130
    v_accvgpr_read_b32 v5, a131
    v_mul_f32 v254, v254, v250
    v_mul_f32 v255, v255, v250
    v_mul_f32 v1, v1, v250
    v_mul_f32 v5, v5, v250
    v_accvgpr_write_b32 a128, v254
    v_accvgpr_write_b32 a129, v255
    v_accvgpr_write_b32 a130, v1
    v_accvgpr_write_b32 a131, v5
    v_accvgpr_read_b32 v254, a132
    v_accvgpr_read_b32 v255, a133
    v_accvgpr_read_b32 v1, a134
    v_accvgpr_read_b32 v5, a135
    v_mul_f32 v254, v254, v248
    v_mul_f32 v255, v255, v248
    v_mul_f32 v1, v1, v248
    v_mul_f32 v5, v5, v248
    v_accvgpr_write_b32 a132, v254
    v_accvgpr_write_b32 a133, v255
    v_accvgpr_write_b32 a134, v1
    v_accvgpr_write_b32 a135, v5
    v_accvgpr_read_b32 v254, a136
    v_accvgpr_read_b32 v255, a137
    v_accvgpr_read_b32 v1, a138
    v_accvgpr_read_b32 v5, a139
    v_mul_f32 v254, v254, v249
    v_mul_f32 v255, v255, v249
    v_mul_f32 v1, v1, v249
    v_mul_f32 v5, v5, v249
    v_accvgpr_write_b32 a136, v254
    v_accvgpr_write_b32 a137, v255
    v_accvgpr_write_b32 a138, v1
    v_accvgpr_write_b32 a139, v5
    v_accvgpr_read_b32 v254, a140
    v_accvgpr_read_b32 v255, a141
    v_accvgpr_read_b32 v1, a142
    v_accvgpr_read_b32 v5, a143
    v_mul_f32 v254, v254, v250
    v_mul_f32 v255, v255, v250
    v_mul_f32 v1, v1, v250
    v_mul_f32 v5, v5, v250
    v_accvgpr_write_b32 a140, v254
    v_accvgpr_write_b32 a141, v255
    v_accvgpr_write_b32 a142, v1
    v_accvgpr_write_b32 a143, v5
    v_accvgpr_read_b32 v254, a144
    v_accvgpr_read_b32 v255, a145
    v_accvgpr_read_b32 v1, a146
    v_accvgpr_read_b32 v5, a147
    v_mul_f32 v254, v254, v248
    v_mul_f32 v255, v255, v248
    v_mul_f32 v1, v1, v248
    v_mul_f32 v5, v5, v248
    v_accvgpr_write_b32 a144, v254
    v_accvgpr_write_b32 a145, v255
    v_accvgpr_write_b32 a146, v1
    v_accvgpr_write_b32 a147, v5
    v_accvgpr_read_b32 v254, a148
    v_accvgpr_read_b32 v255, a149
    v_accvgpr_read_b32 v1, a150
    v_accvgpr_read_b32 v5, a151
    v_mul_f32 v254, v254, v249
    v_mul_f32 v255, v255, v249
    v_mul_f32 v1, v1, v249
    v_mul_f32 v5, v5, v249
    v_accvgpr_write_b32 a148, v254
    v_accvgpr_write_b32 a149, v255
    v_accvgpr_write_b32 a150, v1
    v_accvgpr_write_b32 a151, v5
    v_accvgpr_read_b32 v254, a152
    v_accvgpr_read_b32 v255, a153
    v_accvgpr_read_b32 v1, a154
    v_accvgpr_read_b32 v5, a155
    v_mul_f32 v254, v254, v250
    v_mul_f32 v255, v255, v250
    v_mul_f32 v1, v1, v250
    v_mul_f32 v5, v5, v250
    v_accvgpr_write_b32 a152, v254
    v_accvgpr_write_b32 a153, v255
    v_accvgpr_write_b32 a154, v1
    v_accvgpr_write_b32 a155, v5
    v_accvgpr_read_b32 v254, a156
    v_accvgpr_read_b32 v255, a157
    v_accvgpr_read_b32 v1, a158
    v_accvgpr_read_b32 v5, a159
    v_mul_f32 v254, v254, v248
    v_mul_f32 v255, v255, v248
    v_mul_f32 v1, v1, v248
    v_mul_f32 v5, v5, v248
    v_accvgpr_write_b32 a156, v254
    v_accvgpr_write_b32 a157, v255
    v_accvgpr_write_b32 a158, v1
    v_accvgpr_write_b32 a159, v5
    v_accvgpr_read_b32 v254, a160
    v_accvgpr_read_b32 v255, a161
    v_accvgpr_read_b32 v1, a162
    v_accvgpr_read_b32 v5, a163
    v_mul_f32 v254, v254, v249
    v_mul_f32 v255, v255, v249
    v_mul_f32 v1, v1, v249
    v_mul_f32 v5, v5, v249
    v_accvgpr_write_b32 a160, v254
    v_accvgpr_write_b32 a161, v255
    v_accvgpr_write_b32 a162, v1
    v_accvgpr_write_b32 a163, v5
    v_accvgpr_read_b32 v254, a164
    v_accvgpr_read_b32 v255, a165
    v_accvgpr_read_b32 v1, a166
    v_accvgpr_read_b32 v5, a167
    v_mul_f32 v254, v254, v250
    v_mul_f32 v255, v255, v250
    v_mul_f32 v1, v1, v250
    v_mul_f32 v5, v5, v250
    v_accvgpr_write_b32 a164, v254
    v_accvgpr_write_b32 a165, v255
    v_accvgpr_write_b32 a166, v1
    v_accvgpr_write_b32 a167, v5
    v_accvgpr_read_b32 v254, a168
    v_accvgpr_read_b32 v255, a169
    v_accvgpr_read_b32 v1, a170
    v_accvgpr_read_b32 v5, a171
    v_mul_f32 v254, v254, v248
    v_mul_f32 v255, v255, v248
    v_mul_f32 v1, v1, v248
    v_mul_f32 v5, v5, v248
    v_accvgpr_write_b32 a168, v254
    v_accvgpr_write_b32 a169, v255
    v_accvgpr_write_b32 a170, v1
    v_accvgpr_write_b32 a171, v5
    v_accvgpr_read_b32 v254, a172
    v_accvgpr_read_b32 v255, a173
    v_accvgpr_read_b32 v1, a174
    v_accvgpr_read_b32 v5, a175
    v_mul_f32 v254, v254, v249
    v_mul_f32 v255, v255, v249
    v_mul_f32 v1, v1, v249
    v_mul_f32 v5, v5, v249
    v_accvgpr_write_b32 a172, v254
    v_accvgpr_write_b32 a173, v255
    v_accvgpr_write_b32 a174, v1
    v_accvgpr_write_b32 a175, v5
    v_accvgpr_read_b32 v254, a176
    v_accvgpr_read_b32 v255, a177
    v_accvgpr_read_b32 v1, a178
    v_accvgpr_read_b32 v5, a179
    v_mul_f32 v254, v254, v250
    v_mul_f32 v255, v255, v250
    v_mul_f32 v1, v1, v250
    v_mul_f32 v5, v5, v250
    v_accvgpr_write_b32 a176, v254
    v_accvgpr_write_b32 a177, v255
    v_accvgpr_write_b32 a178, v1
    v_accvgpr_write_b32 a179, v5
    v_accvgpr_read_b32 v254, a180
    v_accvgpr_read_b32 v255, a181
    v_accvgpr_read_b32 v1, a182
    v_accvgpr_read_b32 v5, a183
    v_mul_f32 v254, v254, v248
    v_mul_f32 v255, v255, v248
    v_mul_f32 v1, v1, v248
    v_mul_f32 v5, v5, v248
    v_accvgpr_write_b32 a180, v254
    v_accvgpr_write_b32 a181, v255
    v_accvgpr_write_b32 a182, v1
    v_accvgpr_write_b32 a183, v5
    v_accvgpr_read_b32 v254, a184
    v_accvgpr_read_b32 v255, a185
    v_accvgpr_read_b32 v1, a186
    v_accvgpr_read_b32 v5, a187
    v_mul_f32 v254, v254, v249
    v_mul_f32 v255, v255, v249
    v_mul_f32 v1, v1, v249
    v_mul_f32 v5, v5, v249
    v_accvgpr_write_b32 a184, v254
    v_accvgpr_write_b32 a185, v255
    v_accvgpr_write_b32 a186, v1
    v_accvgpr_write_b32 a187, v5
    v_accvgpr_read_b32 v254, a188
    v_accvgpr_read_b32 v255, a189
    v_accvgpr_read_b32 v1, a190
    v_accvgpr_read_b32 v5, a191
    v_mul_f32 v254, v254, v250
    v_mul_f32 v255, v255, v250
    v_mul_f32 v1, v1, v250
    v_mul_f32 v5, v5, v250
    v_accvgpr_write_b32 a188, v254
    v_accvgpr_write_b32 a189, v255
    v_accvgpr_write_b32 a190, v1
    v_accvgpr_write_b32 a191, v5
    v_fma_f32 v248, v56, s24, v236
    v_fma_f32 v249, v57, s24, v236
    v_fma_f32 v250, v58, s24, v236
    v_fma_f32 v251, v59, s24, v236
    v_exp_f32 v248, v248
    v_exp_f32 v249, v249
    v_fma_f32 v252, v60, s24, v237
    v_fma_f32 v253, v61, s24, v237
    v_exp_f32 v250, v250
    v_exp_f32 v251, v251
    v_add_f32 v242, v248, v249
    v_cvt_pk_bf16_f32 v128, v248, v249
    v_fma_f32 v248, v62, s24, v237
    v_fma_f32 v249, v63, s24, v237
    v_exp_f32 v252, v252
    v_exp_f32 v253, v253
    v_add_f32 v242, v242, v250
    v_add_f32 v242, v242, v251
    v_cvt_pk_bf16_f32 v129, v250, v251
    v_fma_f32 v250, v64, s24, v238
    v_fma_f32 v251, v65, s24, v238
    v_exp_f32 v248, v248
    v_exp_f32 v249, v249
    v_add_f32 v243, v252, v253
    v_cvt_pk_bf16_f32 v132, v252, v253
    v_fma_f32 v252, v66, s24, v238
    v_fma_f32 v253, v67, s24, v238
    v_exp_f32 v250, v250
    v_exp_f32 v251, v251
    v_add_f32 v243, v243, v248
    v_add_f32 v243, v243, v249
    v_cvt_pk_bf16_f32 v133, v248, v249
    v_fma_f32 v248, v68, s24, v236
    v_fma_f32 v249, v69, s24, v236
    v_exp_f32 v252, v252
    v_exp_f32 v253, v253
    v_add_f32 v244, v250, v251
    v_cvt_pk_bf16_f32 v136, v250, v251
    v_fma_f32 v250, v70, s24, v236
    v_fma_f32 v251, v71, s24, v236
    v_exp_f32 v248, v248
    v_exp_f32 v249, v249
    v_add_f32 v244, v244, v252
    v_add_f32 v244, v244, v253
    v_cvt_pk_bf16_f32 v137, v252, v253
    v_fma_f32 v252, v72, s24, v237
    v_fma_f32 v253, v73, s24, v237
    v_exp_f32 v250, v250
    v_exp_f32 v251, v251
    v_add_f32 v242, v242, v248
    v_add_f32 v242, v242, v249
    v_cvt_pk_bf16_f32 v130, v248, v249
    v_fma_f32 v248, v74, s24, v237
    v_fma_f32 v249, v75, s24, v237
    v_exp_f32 v252, v252
    v_exp_f32 v253, v253
    v_add_f32 v242, v242, v250
    v_add_f32 v242, v242, v251
    v_cvt_pk_bf16_f32 v131, v250, v251
    v_fma_f32 v250, v76, s24, v238
    v_fma_f32 v251, v77, s24, v238
    v_exp_f32 v248, v248
    v_exp_f32 v249, v249
    v_add_f32 v243, v243, v252
    v_add_f32 v243, v243, v253
    v_cvt_pk_bf16_f32 v134, v252, v253
    v_fma_f32 v252, v78, s24, v238
    v_fma_f32 v253, v79, s24, v238
    v_exp_f32 v250, v250
    v_exp_f32 v251, v251
    v_add_f32 v243, v243, v248
    v_add_f32 v243, v243, v249
    v_cvt_pk_bf16_f32 v135, v248, v249
    v_exp_f32 v252, v252
    v_exp_f32 v253, v253
    v_add_f32 v244, v244, v250
    v_add_f32 v244, v244, v251
    v_cvt_pk_bf16_f32 v138, v250, v251
    v_add_f32 v244, v244, v252
    v_add_f32 v244, v244, v253
    v_cvt_pk_bf16_f32 v139, v252, v253
    v_fma_f32 v248, v80, s24, v236
    v_fma_f32 v249, v81, s24, v236
    v_fma_f32 v250, v82, s24, v236
    v_fma_f32 v251, v83, s24, v236
    v_exp_f32 v248, v248
    v_exp_f32 v249, v249
    v_fma_f32 v252, v84, s24, v237
    v_fma_f32 v253, v85, s24, v237
    v_exp_f32 v250, v250
    v_exp_f32 v251, v251
    v_add_f32 v245, v248, v249
    v_cvt_pk_bf16_f32 v140, v248, v249
    v_fma_f32 v248, v86, s24, v237
    v_fma_f32 v249, v87, s24, v237
    v_exp_f32 v252, v252
    v_exp_f32 v253, v253
    v_add_f32 v245, v245, v250
    v_add_f32 v245, v245, v251
    v_cvt_pk_bf16_f32 v141, v250, v251
    v_fma_f32 v250, v88, s24, v238
    v_fma_f32 v251, v89, s24, v238
    v_exp_f32 v248, v248
    v_exp_f32 v249, v249
    v_add_f32 v246, v252, v253
    v_cvt_pk_bf16_f32 v144, v252, v253
    v_fma_f32 v252, v90, s24, v238
    v_fma_f32 v253, v91, s24, v238
    v_exp_f32 v250, v250
    v_exp_f32 v251, v251
    v_add_f32 v246, v246, v248
    v_add_f32 v246, v246, v249
    v_cvt_pk_bf16_f32 v145, v248, v249
    v_fma_f32 v248, v92, s24, v236
    v_fma_f32 v249, v93, s24, v236
    v_exp_f32 v252, v252
    v_exp_f32 v253, v253
    v_add_f32 v247, v250, v251
    v_cvt_pk_bf16_f32 v148, v250, v251
    v_fma_f32 v250, v94, s24, v236
    v_fma_f32 v251, v95, s24, v236
    v_exp_f32 v248, v248
    v_exp_f32 v249, v249
    v_add_f32 v247, v247, v252
    v_add_f32 v247, v247, v253
    v_cvt_pk_bf16_f32 v149, v252, v253
    v_fma_f32 v252, v96, s24, v237
    v_fma_f32 v253, v97, s24, v237
    v_exp_f32 v250, v250
    v_exp_f32 v251, v251
    v_add_f32 v245, v245, v248
    v_add_f32 v245, v245, v249
    v_cvt_pk_bf16_f32 v142, v248, v249
    v_fma_f32 v248, v98, s24, v237
    v_fma_f32 v249, v99, s24, v237
    v_exp_f32 v252, v252
    v_exp_f32 v253, v253
    v_add_f32 v245, v245, v250
    v_add_f32 v245, v245, v251
    v_cvt_pk_bf16_f32 v143, v250, v251
    v_fma_f32 v250, v100, s24, v238
    v_fma_f32 v251, v101, s24, v238
    v_exp_f32 v248, v248
    v_exp_f32 v249, v249
    v_add_f32 v246, v246, v252
    v_add_f32 v246, v246, v253
    v_cvt_pk_bf16_f32 v146, v252, v253
    v_fma_f32 v252, v102, s24, v238
    v_fma_f32 v253, v103, s24, v238
    v_exp_f32 v250, v250
    v_exp_f32 v251, v251
    v_add_f32 v246, v246, v248
    v_add_f32 v246, v246, v249
    v_cvt_pk_bf16_f32 v147, v248, v249
    v_exp_f32 v252, v252
    v_exp_f32 v253, v253
    v_add_f32 v247, v247, v250
    v_add_f32 v247, v247, v251
    v_cvt_pk_bf16_f32 v150, v250, v251
    v_add_f32 v247, v247, v252
    v_add_f32 v247, v247, v253
    v_cvt_pk_bf16_f32 v151, v252, v253
    v_add_f32 v254, v242, v245
    v_add_f32 v255, v243, v246
    v_add_f32 v1, v244, v247
    s_branch L_back_l1
L_slow_t0:
    v_max3_f32 v254, v8, v9, v10
    v_max3_f32 v254, v254, v11, v20
    v_max3_f32 v254, v254, v21, v22
    v_max3_f32 v254, v254, v23, v32
    v_max3_f32 v254, v254, v33, v34
    v_max3_f32 v254, v254, v35, v44
    v_max3_f32 v254, v254, v45, v46
    v_max_f32 v254, v254, v47
    v_mov_b32 v255, v254
    s_nop 1
    v_permlane32_swap_b32 v254, v255
    v_max_f32 v254, v254, v255
    v_mov_b32 v255, v254
    s_nop 1
    v_permlane16_swap_b32 v254, v255
    v_max_f32 v254, v254, v255
    v_max_f32 v254, v254, v2
    v_sub_f32 v255, v2, v254
    v_mul_f32 v255, s24, v255
    v_exp_f32 v248, v255
    v_mov_b32 v2, v254
    v_mul_f32 v236, -v254, s24
    v_mul_f32 v239, v239, v248
    v_max3_f32 v254, v12, v13, v14
    v_max3_f32 v254, v254, v15, v24
    v_max3_f32 v254, v254, v25, v26
    v_max3_f32 v254, v254, v27, v36
    v_max3_f32 v254, v254, v37, v38
    v_max3_f32 v254, v254, v39, v48
    v_max3_f32 v254, v254, v49, v50
    v_max_f32 v254, v254, v51
    v_mov_b32 v255, v254
    s_nop 1
    v_permlane32_swap_b32 v254, v255
    v_max_f32 v254, v254, v255
    v_mov_b32 v255, v254
    s_nop 1
    v_permlane16_swap_b32 v254, v255
    v_max_f32 v254, v254, v255
    v_max_f32 v254, v254, v3
    v_sub_f32 v255, v3, v254
    v_mul_f32 v255, s24, v255
    v_exp_f32 v249, v255
    v_mov_b32 v3, v254
    v_mul_f32 v237, -v254, s24
    v_mul_f32 v240, v240, v249
    v_max3_f32 v254, v16, v17, v18
    v_max3_f32 v254, v254, v19, v28
    v_max3_f32 v254, v254, v29, v30
    v_max3_f32 v254, v254, v31, v40
    v_max3_f32 v254, v254, v41, v42
    v_max3_f32 v254, v254, v43, v52
    v_max3_f32 v254, v254, v53, v54
    v_max_f32 v254, v254, v55
    v_mov_b32 v255, v254
    s_nop 1
    v_permlane32_swap_b32 v254, v255
    v_max_f32 v254, v254, v255
    v_mov_b32 v255, v254
    s_nop 1
    v_permlane16_swap_b32 v254, v255
    v_max_f32 v254, v254, v255
    v_max_f32 v254, v254, v4
    v_sub_f32 v255, v4, v254
    v_mul_f32 v255, s24, v255
    v_exp_f32 v250, v255
    v_mov_b32 v4, v254
    v_mul_f32 v238, -v254, s24
    v_mul_f32 v241, v241, v250
    v_accvgpr_read_b32 v254, a0
    v_accvgpr_read_b32 v255, a1
    v_accvgpr_read_b32 v1, a2
    v_accvgpr_read_b32 v5, a3
    v_mul_f32 v254, v254, v248
    v_mul_f32 v255, v255, v248
    v_mul_f32 v1, v1, v248
    v_mul_f32 v5, v5, v248
    v_accvgpr_write_b32 a0, v254
    v_accvgpr_write_b32 a1, v255
    v_accvgpr_write_b32 a2, v1
    v_accvgpr_write_b32 a3, v5
    v_accvgpr_read_b32 v254, a4
    v_accvgpr_read_b32 v255, a5
    v_accvgpr_read_b32 v1, a6
    v_accvgpr_read_b32 v5, a7
    v_mul_f32 v254, v254, v249
    v_mul_f32 v255, v255, v249
    v_mul_f32 v1, v1, v249
    v_mul_f32 v5, v5, v249
    v_accvgpr_write_b32 a4, v254
    v_accvgpr_write_b32 a5, v255
    v_accvgpr_write_b32 a6, v1
    v_accvgpr_write_b32 a7, v5
    v_accvgpr_read_b32 v254, a8
    v_accvgpr_read_b32 v255, a9
    v_accvgpr_read_b32 v1, a10
    v_accvgpr_read_b32 v5, a11
    v_mul_f32 v254, v254, v250
    v_mul_f32 v255, v255, v250
    v_mul_f32 v1, v1, v250
    v_mul_f32 v5, v5, v250
    v_accvgpr_write_b32 a8, v254
    v_accvgpr_write_b32 a9, v255
    v_accvgpr_write_b32 a10, v1
    v_accvgpr_write_b32 a11, v5
    v_accvgpr_read_b32 v254, a12
    v_accvgpr_read_b32 v255, a13
    v_accvgpr_read_b32 v1, a14
    v_accvgpr_read_b32 v5, a15
    v_mul_f32 v254, v254, v248
    v_mul_f32 v255, v255, v248
    v_mul_f32 v1, v1, v248
    v_mul_f32 v5, v5, v248
    v_accvgpr_write_b32 a12, v254
    v_accvgpr_write_b32 a13, v255
    v_accvgpr_write_b32 a14, v1
    v_accvgpr_write_b32 a15, v5
    v_accvgpr_read_b32 v254, a16
    v_accvgpr_read_b32 v255, a17
    v_accvgpr_read_b32 v1, a18
    v_accvgpr_read_b32 v5, a19
    v_mul_f32 v254, v254, v249
    v_mul_f32 v255, v255, v249
    v_mul_f32 v1, v1, v249
    v_mul_f32 v5, v5, v249
    v_accvgpr_write_b32 a16, v254
    v_accvgpr_write_b32 a17, v255
    v_accvgpr_write_b32 a18, v1
    v_accvgpr_write_b32 a19, v5
    v_accvgpr_read_b32 v254, a20
    v_accvgpr_read_b32 v255, a21
    v_accvgpr_read_b32 v1, a22
    v_accvgpr_read_b32 v5, a23
    v_mul_f32 v254, v254, v250
    v_mul_f32 v255, v255, v250
    v_mul_f32 v1, v1, v250
    v_mul_f32 v5, v5, v250
    v_accvgpr_write_b32 a20, v254
    v_accvgpr_write_b32 a21, v255
    v_accvgpr_write_b32 a22, v1
    v_accvgpr_write_b32 a23, v5
    v_accvgpr_read_b32 v254, a24
    v_accvgpr_read_b32 v255, a25
    v_accvgpr_read_b32 v1, a26
    v_accvgpr_read_b32 v5, a27
    v_mul_f32 v254, v254, v248
    v_mul_f32 v255, v255, v248
    v_mul_f32 v1, v1, v248
    v_mul_f32 v5, v5, v248
    v_accvgpr_write_b32 a24, v254
    v_accvgpr_write_b32 a25, v255
    v_accvgpr_write_b32 a26, v1
    v_accvgpr_write_b32 a27, v5
    v_accvgpr_read_b32 v254, a28
    v_accvgpr_read_b32 v255, a29
    v_accvgpr_read_b32 v1, a30
    v_accvgpr_read_b32 v5, a31
    v_mul_f32 v254, v254, v249
    v_mul_f32 v255, v255, v249
    v_mul_f32 v1, v1, v249
    v_mul_f32 v5, v5, v249
    v_accvgpr_write_b32 a28, v254
    v_accvgpr_write_b32 a29, v255
    v_accvgpr_write_b32 a30, v1
    v_accvgpr_write_b32 a31, v5
    v_accvgpr_read_b32 v254, a32
    v_accvgpr_read_b32 v255, a33
    v_accvgpr_read_b32 v1, a34
    v_accvgpr_read_b32 v5, a35
    v_mul_f32 v254, v254, v250
    v_mul_f32 v255, v255, v250
    v_mul_f32 v1, v1, v250
    v_mul_f32 v5, v5, v250
    v_accvgpr_write_b32 a32, v254
    v_accvgpr_write_b32 a33, v255
    v_accvgpr_write_b32 a34, v1
    v_accvgpr_write_b32 a35, v5
    v_accvgpr_read_b32 v254, a36
    v_accvgpr_read_b32 v255, a37
    v_accvgpr_read_b32 v1, a38
    v_accvgpr_read_b32 v5, a39
    v_mul_f32 v254, v254, v248
    v_mul_f32 v255, v255, v248
    v_mul_f32 v1, v1, v248
    v_mul_f32 v5, v5, v248
    v_accvgpr_write_b32 a36, v254
    v_accvgpr_write_b32 a37, v255
    v_accvgpr_write_b32 a38, v1
    v_accvgpr_write_b32 a39, v5
    v_accvgpr_read_b32 v254, a40
    v_accvgpr_read_b32 v255, a41
    v_accvgpr_read_b32 v1, a42
    v_accvgpr_read_b32 v5, a43
    v_mul_f32 v254, v254, v249
    v_mul_f32 v255, v255, v249
    v_mul_f32 v1, v1, v249
    v_mul_f32 v5, v5, v249
    v_accvgpr_write_b32 a40, v254
    v_accvgpr_write_b32 a41, v255
    v_accvgpr_write_b32 a42, v1
    v_accvgpr_write_b32 a43, v5
    v_accvgpr_read_b32 v254, a44
    v_accvgpr_read_b32 v255, a45
    v_accvgpr_read_b32 v1, a46
    v_accvgpr_read_b32 v5, a47
    v_mul_f32 v254, v254, v250
    v_mul_f32 v255, v255, v250
    v_mul_f32 v1, v1, v250
    v_mul_f32 v5, v5, v250
    v_accvgpr_write_b32 a44, v254
    v_accvgpr_write_b32 a45, v255
    v_accvgpr_write_b32 a46, v1
    v_accvgpr_write_b32 a47, v5
    v_accvgpr_read_b32 v254, a48
    v_accvgpr_read_b32 v255, a49
    v_accvgpr_read_b32 v1, a50
    v_accvgpr_read_b32 v5, a51
    v_mul_f32 v254, v254, v248
    v_mul_f32 v255, v255, v248
    v_mul_f32 v1, v1, v248
    v_mul_f32 v5, v5, v248
    v_accvgpr_write_b32 a48, v254
    v_accvgpr_write_b32 a49, v255
    v_accvgpr_write_b32 a50, v1
    v_accvgpr_write_b32 a51, v5
    v_accvgpr_read_b32 v254, a52
    v_accvgpr_read_b32 v255, a53
    v_accvgpr_read_b32 v1, a54
    v_accvgpr_read_b32 v5, a55
    v_mul_f32 v254, v254, v249
    v_mul_f32 v255, v255, v249
    v_mul_f32 v1, v1, v249
    v_mul_f32 v5, v5, v249
    v_accvgpr_write_b32 a52, v254
    v_accvgpr_write_b32 a53, v255
    v_accvgpr_write_b32 a54, v1
    v_accvgpr_write_b32 a55, v5
    v_accvgpr_read_b32 v254, a56
    v_accvgpr_read_b32 v255, a57
    v_accvgpr_read_b32 v1, a58
    v_accvgpr_read_b32 v5, a59
    v_mul_f32 v254, v254, v250
    v_mul_f32 v255, v255, v250
    v_mul_f32 v1, v1, v250
    v_mul_f32 v5, v5, v250
    v_accvgpr_write_b32 a56, v254
    v_accvgpr_write_b32 a57, v255
    v_accvgpr_write_b32 a58, v1
    v_accvgpr_write_b32 a59, v5
    v_accvgpr_read_b32 v254, a60
    v_accvgpr_read_b32 v255, a61
    v_accvgpr_read_b32 v1, a62
    v_accvgpr_read_b32 v5, a63
    v_mul_f32 v254, v254, v248
    v_mul_f32 v255, v255, v248
    v_mul_f32 v1, v1, v248
    v_mul_f32 v5, v5, v248
    v_accvgpr_write_b32 a60, v254
    v_accvgpr_write_b32 a61, v255
    v_accvgpr_write_b32 a62, v1
    v_accvgpr_write_b32 a63, v5
    v_accvgpr_read_b32 v254, a64
    v_accvgpr_read_b32 v255, a65
    v_accvgpr_read_b32 v1, a66
    v_accvgpr_read_b32 v5, a67
    v_mul_f32 v254, v254, v249
    v_mul_f32 v255, v255, v249
    v_mul_f32 v1, v1, v249
    v_mul_f32 v5, v5, v249
    v_accvgpr_write_b32 a64, v254
    v_accvgpr_write_b32 a65, v255
    v_accvgpr_write_b32 a66, v1
    v_accvgpr_write_b32 a67, v5
    v_accvgpr_read_b32 v254, a68
    v_accvgpr_read_b32 v255, a69
    v_accvgpr_read_b32 v1, a70
    v_accvgpr_read_b32 v5, a71
    v_mul_f32 v254, v254, v250
    v_mul_f32 v255, v255, v250
    v_mul_f32 v1, v1, v250
    v_mul_f32 v5, v5, v250
    v_accvgpr_write_b32 a68, v254
    v_accvgpr_write_b32 a69, v255
    v_accvgpr_write_b32 a70, v1
    v_accvgpr_write_b32 a71, v5
    v_accvgpr_read_b32 v254, a72
    v_accvgpr_read_b32 v255, a73
    v_accvgpr_read_b32 v1, a74
    v_accvgpr_read_b32 v5, a75
    v_mul_f32 v254, v254, v248
    v_mul_f32 v255, v255, v248
    v_mul_f32 v1, v1, v248
    v_mul_f32 v5, v5, v248
    v_accvgpr_write_b32 a72, v254
    v_accvgpr_write_b32 a73, v255
    v_accvgpr_write_b32 a74, v1
    v_accvgpr_write_b32 a75, v5
    v_accvgpr_read_b32 v254, a76
    v_accvgpr_read_b32 v255, a77
    v_accvgpr_read_b32 v1, a78
    v_accvgpr_read_b32 v5, a79
    v_mul_f32 v254, v254, v249
    v_mul_f32 v255, v255, v249
    v_mul_f32 v1, v1, v249
    v_mul_f32 v5, v5, v249
    v_accvgpr_write_b32 a76, v254
    v_accvgpr_write_b32 a77, v255
    v_accvgpr_write_b32 a78, v1
    v_accvgpr_write_b32 a79, v5
    v_accvgpr_read_b32 v254, a80
    v_accvgpr_read_b32 v255, a81
    v_accvgpr_read_b32 v1, a82
    v_accvgpr_read_b32 v5, a83
    v_mul_f32 v254, v254, v250
    v_mul_f32 v255, v255, v250
    v_mul_f32 v1, v1, v250
    v_mul_f32 v5, v5, v250
    v_accvgpr_write_b32 a80, v254
    v_accvgpr_write_b32 a81, v255
    v_accvgpr_write_b32 a82, v1
    v_accvgpr_write_b32 a83, v5
    v_accvgpr_read_b32 v254, a84
    v_accvgpr_read_b32 v255, a85
    v_accvgpr_read_b32 v1, a86
    v_accvgpr_read_b32 v5, a87
    v_mul_f32 v254, v254, v248
    v_mul_f32 v255, v255, v248
    v_mul_f32 v1, v1, v248
    v_mul_f32 v5, v5, v248
    v_accvgpr_write_b32 a84, v254
    v_accvgpr_write_b32 a85, v255
    v_accvgpr_write_b32 a86, v1
    v_accvgpr_write_b32 a87, v5
    v_accvgpr_read_b32 v254, a88
    v_accvgpr_read_b32 v255, a89
    v_accvgpr_read_b32 v1, a90
    v_accvgpr_read_b32 v5, a91
    v_mul_f32 v254, v254, v249
    v_mul_f32 v255, v255, v249
    v_mul_f32 v1, v1, v249
    v_mul_f32 v5, v5, v249
    v_accvgpr_write_b32 a88, v254
    v_accvgpr_write_b32 a89, v255
    v_accvgpr_write_b32 a90, v1
    v_accvgpr_write_b32 a91, v5
    v_accvgpr_read_b32 v254, a92
    v_accvgpr_read_b32 v255, a93
    v_accvgpr_read_b32 v1, a94
    v_accvgpr_read_b32 v5, a95
    v_mul_f32 v254, v254, v250
    v_mul_f32 v255, v255, v250
    v_mul_f32 v1, v1, v250
    v_mul_f32 v5, v5, v250
    v_accvgpr_write_b32 a92, v254
    v_accvgpr_write_b32 a93, v255
    v_accvgpr_write_b32 a94, v1
    v_accvgpr_write_b32 a95, v5
    v_accvgpr_read_b32 v254, a96
    v_accvgpr_read_b32 v255, a97
    v_accvgpr_read_b32 v1, a98
    v_accvgpr_read_b32 v5, a99
    v_mul_f32 v254, v254, v248
    v_mul_f32 v255, v255, v248
    v_mul_f32 v1, v1, v248
    v_mul_f32 v5, v5, v248
    v_accvgpr_write_b32 a96, v254
    v_accvgpr_write_b32 a97, v255
    v_accvgpr_write_b32 a98, v1
    v_accvgpr_write_b32 a99, v5
    v_accvgpr_read_b32 v254, a100
    v_accvgpr_read_b32 v255, a101
    v_accvgpr_read_b32 v1, a102
    v_accvgpr_read_b32 v5, a103
    v_mul_f32 v254, v254, v249
    v_mul_f32 v255, v255, v249
    v_mul_f32 v1, v1, v249
    v_mul_f32 v5, v5, v249
    v_accvgpr_write_b32 a100, v254
    v_accvgpr_write_b32 a101, v255
    v_accvgpr_write_b32 a102, v1
    v_accvgpr_write_b32 a103, v5
    v_accvgpr_read_b32 v254, a104
    v_accvgpr_read_b32 v255, a105
    v_accvgpr_read_b32 v1, a106
    v_accvgpr_read_b32 v5, a107
    v_mul_f32 v254, v254, v250
    v_mul_f32 v255, v255, v250
    v_mul_f32 v1, v1, v250
    v_mul_f32 v5, v5, v250
    v_accvgpr_write_b32 a104, v254
    v_accvgpr_write_b32 a105, v255
    v_accvgpr_write_b32 a106, v1
    v_accvgpr_write_b32 a107, v5
    v_accvgpr_read_b32 v254, a108
    v_accvgpr_read_b32 v255, a109
    v_accvgpr_read_b32 v1, a110
    v_accvgpr_read_b32 v5, a111
    v_mul_f32 v254, v254, v248
    v_mul_f32 v255, v255, v248
    v_mul_f32 v1, v1, v248
    v_mul_f32 v5, v5, v248
    v_accvgpr_write_b32 a108, v254
    v_accvgpr_write_b32 a109, v255
    v_accvgpr_write_b32 a110, v1
    v_accvgpr_write_b32 a111, v5
    v_accvgpr_read_b32 v254, a112
    v_accvgpr_read_b32 v255, a113
    v_accvgpr_read_b32 v1, a114
    v_accvgpr_read_b32 v5, a115
    v_mul_f32 v254, v254, v249
    v_mul_f32 v255, v255, v249
    v_mul_f32 v1, v1, v249
    v_mul_f32 v5, v5, v249
    v_accvgpr_write_b32 a112, v254
    v_accvgpr_write_b32 a113, v255
    v_accvgpr_write_b32 a114, v1
    v_accvgpr_write_b32 a115, v5
    v_accvgpr_read_b32 v254, a116
    v_accvgpr_read_b32 v255, a117
    v_accvgpr_read_b32 v1, a118
    v_accvgpr_read_b32 v5, a119
    v_mul_f32 v254, v254, v250
    v_mul_f32 v255, v255, v250
    v_mul_f32 v1, v1, v250
    v_mul_f32 v5, v5, v250
    v_accvgpr_write_b32 a116, v254
    v_accvgpr_write_b32 a117, v255
    v_accvgpr_write_b32 a118, v1
    v_accvgpr_write_b32 a119, v5
    v_accvgpr_read_b32 v254, a120
    v_accvgpr_read_b32 v255, a121
    v_accvgpr_read_b32 v1, a122
    v_accvgpr_read_b32 v5, a123
    v_mul_f32 v254, v254, v248
    v_mul_f32 v255, v255, v248
    v_mul_f32 v1, v1, v248
    v_mul_f32 v5, v5, v248
    v_accvgpr_write_b32 a120, v254
    v_accvgpr_write_b32 a121, v255
    v_accvgpr_write_b32 a122, v1
    v_accvgpr_write_b32 a123, v5
    v_accvgpr_read_b32 v254, a124
    v_accvgpr_read_b32 v255, a125
    v_accvgpr_read_b32 v1, a126
    v_accvgpr_read_b32 v5, a127
    v_mul_f32 v254, v254, v249
    v_mul_f32 v255, v255, v249
    v_mul_f32 v1, v1, v249
    v_mul_f32 v5, v5, v249
    v_accvgpr_write_b32 a124, v254
    v_accvgpr_write_b32 a125, v255
    v_accvgpr_write_b32 a126, v1
    v_accvgpr_write_b32 a127, v5
    v_accvgpr_read_b32 v254, a128
    v_accvgpr_read_b32 v255, a129
    v_accvgpr_read_b32 v1, a130
    v_accvgpr_read_b32 v5, a131
    v_mul_f32 v254, v254, v250
    v_mul_f32 v255, v255, v250
    v_mul_f32 v1, v1, v250
    v_mul_f32 v5, v5, v250
    v_accvgpr_write_b32 a128, v254
    v_accvgpr_write_b32 a129, v255
    v_accvgpr_write_b32 a130, v1
    v_accvgpr_write_b32 a131, v5
    v_accvgpr_read_b32 v254, a132
    v_accvgpr_read_b32 v255, a133
    v_accvgpr_read_b32 v1, a134
    v_accvgpr_read_b32 v5, a135
    v_mul_f32 v254, v254, v248
    v_mul_f32 v255, v255, v248
    v_mul_f32 v1, v1, v248
    v_mul_f32 v5, v5, v248
    v_accvgpr_write_b32 a132, v254
    v_accvgpr_write_b32 a133, v255
    v_accvgpr_write_b32 a134, v1
    v_accvgpr_write_b32 a135, v5
    v_accvgpr_read_b32 v254, a136
    v_accvgpr_read_b32 v255, a137
    v_accvgpr_read_b32 v1, a138
    v_accvgpr_read_b32 v5, a139
    v_mul_f32 v254, v254, v249
    v_mul_f32 v255, v255, v249
    v_mul_f32 v1, v1, v249
    v_mul_f32 v5, v5, v249
    v_accvgpr_write_b32 a136, v254
    v_accvgpr_write_b32 a137, v255
    v_accvgpr_write_b32 a138, v1
    v_accvgpr_write_b32 a139, v5
    v_accvgpr_read_b32 v254, a140
    v_accvgpr_read_b32 v255, a141
    v_accvgpr_read_b32 v1, a142
    v_accvgpr_read_b32 v5, a143
    v_mul_f32 v254, v254, v250
    v_mul_f32 v255, v255, v250
    v_mul_f32 v1, v1, v250
    v_mul_f32 v5, v5, v250
    v_accvgpr_write_b32 a140, v254
    v_accvgpr_write_b32 a141, v255
    v_accvgpr_write_b32 a142, v1
    v_accvgpr_write_b32 a143, v5
    v_accvgpr_read_b32 v254, a144
    v_accvgpr_read_b32 v255, a145
    v_accvgpr_read_b32 v1, a146
    v_accvgpr_read_b32 v5, a147
    v_mul_f32 v254, v254, v248
    v_mul_f32 v255, v255, v248
    v_mul_f32 v1, v1, v248
    v_mul_f32 v5, v5, v248
    v_accvgpr_write_b32 a144, v254
    v_accvgpr_write_b32 a145, v255
    v_accvgpr_write_b32 a146, v1
    v_accvgpr_write_b32 a147, v5
    v_accvgpr_read_b32 v254, a148
    v_accvgpr_read_b32 v255, a149
    v_accvgpr_read_b32 v1, a150
    v_accvgpr_read_b32 v5, a151
    v_mul_f32 v254, v254, v249
    v_mul_f32 v255, v255, v249
    v_mul_f32 v1, v1, v249
    v_mul_f32 v5, v5, v249
    v_accvgpr_write_b32 a148, v254
    v_accvgpr_write_b32 a149, v255
    v_accvgpr_write_b32 a150, v1
    v_accvgpr_write_b32 a151, v5
    v_accvgpr_read_b32 v254, a152
    v_accvgpr_read_b32 v255, a153
    v_accvgpr_read_b32 v1, a154
    v_accvgpr_read_b32 v5, a155
    v_mul_f32 v254, v254, v250
    v_mul_f32 v255, v255, v250
    v_mul_f32 v1, v1, v250
    v_mul_f32 v5, v5, v250
    v_accvgpr_write_b32 a152, v254
    v_accvgpr_write_b32 a153, v255
    v_accvgpr_write_b32 a154, v1
    v_accvgpr_write_b32 a155, v5
    v_accvgpr_read_b32 v254, a156
    v_accvgpr_read_b32 v255, a157
    v_accvgpr_read_b32 v1, a158
    v_accvgpr_read_b32 v5, a159
    v_mul_f32 v254, v254, v248
    v_mul_f32 v255, v255, v248
    v_mul_f32 v1, v1, v248
    v_mul_f32 v5, v5, v248
    v_accvgpr_write_b32 a156, v254
    v_accvgpr_write_b32 a157, v255
    v_accvgpr_write_b32 a158, v1
    v_accvgpr_write_b32 a159, v5
    v_accvgpr_read_b32 v254, a160
    v_accvgpr_read_b32 v255, a161
    v_accvgpr_read_b32 v1, a162
    v_accvgpr_read_b32 v5, a163
    v_mul_f32 v254, v254, v249
    v_mul_f32 v255, v255, v249
    v_mul_f32 v1, v1, v249
    v_mul_f32 v5, v5, v249
    v_accvgpr_write_b32 a160, v254
    v_accvgpr_write_b32 a161, v255
    v_accvgpr_write_b32 a162, v1
    v_accvgpr_write_b32 a163, v5
    v_accvgpr_read_b32 v254, a164
    v_accvgpr_read_b32 v255, a165
    v_accvgpr_read_b32 v1, a166
    v_accvgpr_read_b32 v5, a167
    v_mul_f32 v254, v254, v250
    v_mul_f32 v255, v255, v250
    v_mul_f32 v1, v1, v250
    v_mul_f32 v5, v5, v250
    v_accvgpr_write_b32 a164, v254
    v_accvgpr_write_b32 a165, v255
    v_accvgpr_write_b32 a166, v1
    v_accvgpr_write_b32 a167, v5
    v_accvgpr_read_b32 v254, a168
    v_accvgpr_read_b32 v255, a169
    v_accvgpr_read_b32 v1, a170
    v_accvgpr_read_b32 v5, a171
    v_mul_f32 v254, v254, v248
    v_mul_f32 v255, v255, v248
    v_mul_f32 v1, v1, v248
    v_mul_f32 v5, v5, v248
    v_accvgpr_write_b32 a168, v254
    v_accvgpr_write_b32 a169, v255
    v_accvgpr_write_b32 a170, v1
    v_accvgpr_write_b32 a171, v5
    v_accvgpr_read_b32 v254, a172
    v_accvgpr_read_b32 v255, a173
    v_accvgpr_read_b32 v1, a174
    v_accvgpr_read_b32 v5, a175
    v_mul_f32 v254, v254, v249
    v_mul_f32 v255, v255, v249
    v_mul_f32 v1, v1, v249
    v_mul_f32 v5, v5, v249
    v_accvgpr_write_b32 a172, v254
    v_accvgpr_write_b32 a173, v255
    v_accvgpr_write_b32 a174, v1
    v_accvgpr_write_b32 a175, v5
    v_accvgpr_read_b32 v254, a176
    v_accvgpr_read_b32 v255, a177
    v_accvgpr_read_b32 v1, a178
    v_accvgpr_read_b32 v5, a179
    v_mul_f32 v254, v254, v250
    v_mul_f32 v255, v255, v250
    v_mul_f32 v1, v1, v250
    v_mul_f32 v5, v5, v250
    v_accvgpr_write_b32 a176, v254
    v_accvgpr_write_b32 a177, v255
    v_accvgpr_write_b32 a178, v1
    v_accvgpr_write_b32 a179, v5
    v_accvgpr_read_b32 v254, a180
    v_accvgpr_read_b32 v255, a181
    v_accvgpr_read_b32 v1, a182
    v_accvgpr_read_b32 v5, a183
    v_mul_f32 v254, v254, v248
    v_mul_f32 v255, v255, v248
    v_mul_f32 v1, v1, v248
    v_mul_f32 v5, v5, v248
    v_accvgpr_write_b32 a180, v254
    v_accvgpr_write_b32 a181, v255
    v_accvgpr_write_b32 a182, v1
    v_accvgpr_write_b32 a183, v5
    v_accvgpr_read_b32 v254, a184
    v_accvgpr_read_b32 v255, a185
    v_accvgpr_read_b32 v1, a186
    v_accvgpr_read_b32 v5, a187
    v_mul_f32 v254, v254, v249
    v_mul_f32 v255, v255, v249
    v_mul_f32 v1, v1, v249
    v_mul_f32 v5, v5, v249
    v_accvgpr_write_b32 a184, v254
    v_accvgpr_write_b32 a185, v255
    v_accvgpr_write_b32 a186, v1
    v_accvgpr_write_b32 a187, v5
    v_accvgpr_read_b32 v254, a188
    v_accvgpr_read_b32 v255, a189
    v_accvgpr_read_b32 v1, a190
    v_accvgpr_read_b32 v5, a191
    v_mul_f32 v254, v254, v250
    v_mul_f32 v255, v255, v250
    v_mul_f32 v1, v1, v250
    v_mul_f32 v5, v5, v250
    v_accvgpr_write_b32 a188, v254
    v_accvgpr_write_b32 a189, v255
    v_accvgpr_write_b32 a190, v1
    v_accvgpr_write_b32 a191, v5
    v_fma_f32 v248, v8, s24, v236
    v_fma_f32 v249, v9, s24, v236
    v_fma_f32 v250, v10, s24, v236
    v_fma_f32 v251, v11, s24, v236
    v_exp_f32 v248, v248
    v_exp_f32 v249, v249
    v_fma_f32 v252, v12, s24, v237
    v_fma_f32 v253, v13, s24, v237
    v_exp_f32 v250, v250
    v_exp_f32 v251, v251
    v_add_f32 v242, v248, v249
    v_cvt_pk_bf16_f32 v104, v248, v249
    v_fma_f32 v248, v14, s24, v237
    v_fma_f32 v249, v15, s24, v237
    v_exp_f32 v252, v252
    v_exp_f32 v253, v253
    v_add_f32 v242, v242, v250
    v_add_f32 v242, v242, v251
    v_cvt_pk_bf16_f32 v105, v250, v251
    v_fma_f32 v250, v16, s24, v238
    v_fma_f32 v251, v17, s24, v238
    v_exp_f32 v248, v248
    v_exp_f32 v249, v249
    v_add_f32 v243, v252, v253
    v_cvt_pk_bf16_f32 v108, v252, v253
    v_fma_f32 v252, v18, s24, v238
    v_fma_f32 v253, v19, s24, v238
    v_exp_f32 v250, v250
    v_exp_f32 v251, v251
    v_add_f32 v243, v243, v248
    v_add_f32 v243, v243, v249
    v_cvt_pk_bf16_f32 v109, v248, v249
    v_fma_f32 v248, v20, s24, v236
    v_fma_f32 v249, v21, s24, v236
    v_exp_f32 v252, v252
    v_exp_f32 v253, v253
    v_add_f32 v244, v250, v251
    v_cvt_pk_bf16_f32 v112, v250, v251
    v_fma_f32 v250, v22, s24, v236
    v_fma_f32 v251, v23, s24, v236
    v_exp_f32 v248, v248
    v_exp_f32 v249, v249
    v_add_f32 v244, v244, v252
    v_add_f32 v244, v244, v253
    v_cvt_pk_bf16_f32 v113, v252, v253
    v_fma_f32 v252, v24, s24, v237
    v_fma_f32 v253, v25, s24, v237
    v_exp_f32 v250, v250
    v_exp_f32 v251, v251
    v_add_f32 v242, v242, v248
    v_add_f32 v242, v242, v249
    v_cvt_pk_bf16_f32 v106, v248, v249
    v_fma_f32 v248, v26, s24, v237
    v_fma_f32 v249, v27, s24, v237
    v_exp_f32 v252, v252
    v_exp_f32 v253, v253
    v_add_f32 v242, v242, v250
    v_add_f32 v242, v242, v251
    v_cvt_pk_bf16_f32 v107, v250, v251
    v_fma_f32 v250, v28, s24, v238
    v_fma_f32 v251, v29, s24, v238
    v_exp_f32 v248, v248
    v_exp_f32 v249, v249
    v_add_f32 v243, v243, v252
    v_add_f32 v243, v243, v253
    v_cvt_pk_bf16_f32 v110, v252, v253
    v_fma_f32 v252, v30, s24, v238
    v_fma_f32 v253, v31, s24, v238
    v_exp_f32 v250, v250
    v_exp_f32 v251, v251
    v_add_f32 v243, v243, v248
    v_add_f32 v243, v243, v249
    v_cvt_pk_bf16_f32 v111, v248, v249
    v_exp_f32 v252, v252
    v_exp_f32 v253, v253
    v_add_f32 v244, v244, v250
    v_add_f32 v244, v244, v251
    v_cvt_pk_bf16_f32 v114, v250, v251
    v_add_f32 v244, v244, v252
    v_add_f32 v244, v244, v253
    v_cvt_pk_bf16_f32 v115, v252, v253
    v_fma_f32 v248, v32, s24, v236
    v_fma_f32 v249, v33, s24, v236
    v_fma_f32 v250, v34, s24, v236
    v_fma_f32 v251, v35, s24, v236
    v_exp_f32 v248, v248
    v_exp_f32 v249, v249
    v_fma_f32 v252, v36, s24, v237
    v_fma_f32 v253, v37, s24, v237
    v_exp_f32 v250, v250
    v_exp_f32 v251, v251
    v_add_f32 v245, v248, v249
    v_cvt_pk_bf16_f32 v116, v248, v249
    v_fma_f32 v248, v38, s24, v237
    v_fma_f32 v249, v39, s24, v237
    v_exp_f32 v252, v252
    v_exp_f32 v253, v253
    v_add_f32 v245, v245, v250
    v_add_f32 v245, v245, v251
    v_cvt_pk_bf16_f32 v117, v250, v251
    v_fma_f32 v250, v40, s24, v238
    v_fma_f32 v251, v41, s24, v238
    v_exp_f32 v248, v248
    v_exp_f32 v249, v249
    v_add_f32 v246, v252, v253
    v_cvt_pk_bf16_f32 v120, v252, v253
    v_fma_f32 v252, v42, s24, v238
    v_fma_f32 v253, v43, s24, v238
    v_exp_f32 v250, v250
    v_exp_f32 v251, v251
    v_add_f32 v246, v246, v248
    v_add_f32 v246, v246, v249
    v_cvt_pk_bf16_f32 v121, v248, v249
    v_fma_f32 v248, v44, s24, v236
    v_fma_f32 v249, v45, s24, v236
    v_exp_f32 v252, v252
    v_exp_f32 v253, v253
    v_add_f32 v247, v250, v251
    v_cvt_pk_bf16_f32 v124, v250, v251
    v_fma_f32 v250, v46, s24, v236
    v_fma_f32 v251, v47, s24, v236
    v_exp_f32 v248, v248
    v_exp_f32 v249, v249
    v_add_f32 v247, v247, v252
    v_add_f32 v247, v247, v253
    v_cvt_pk_bf16_f32 v125, v252, v253
    v_fma_f32 v252, v48, s24, v237
    v_fma_f32 v253, v49, s24, v237
    v_exp_f32 v250, v250
    v_exp_f32 v251, v251
    v_add_f32 v245, v245, v248
    v_add_f32 v245, v245, v249
    v_cvt_pk_bf16_f32 v118, v248, v249
    v_fma_f32 v248, v50, s24, v237
    v_fma_f32 v249, v51, s24, v237
    v_exp_f32 v252, v252
    v_exp_f32 v253, v253
    v_add_f32 v245, v245, v250
    v_add_f32 v245, v245, v251
    v_cvt_pk_bf16_f32 v119, v250, v251
    v_fma_f32 v250, v52, s24, v238
    v_fma_f32 v251, v53, s24, v238
    v_exp_f32 v248, v248
    v_exp_f32 v249, v249
    v_add_f32 v246, v246, v252
    v_add_f32 v246, v246, v253
    v_cvt_pk_bf16_f32 v122, v252, v253
    v_fma_f32 v252, v54, s24, v238
    v_fma_f32 v253, v55, s24, v238
    v_exp_f32 v250, v250
    v_exp_f32 v251, v251
    v_add_f32 v246, v246, v248
    v_add_f32 v246, v246, v249
    v_cvt_pk_bf16_f32 v123, v248, v249
    v_exp_f32 v252, v252
    v_exp_f32 v253, v253
    v_add_f32 v247, v247, v250
    v_add_f32 v247, v247, v251
    v_cvt_pk_bf16_f32 v126, v250, v251
    v_add_f32 v247, v247, v252
    v_add_f32 v247, v247, v253
    v_cvt_pk_bf16_f32 v127, v252, v253
    v_add_f32 v254, v242, v245
    v_add_f32 v255, v243, v246
    v_add_f32 v1, v244, v247
    s_branch L_back_t0
L_slow_t1:
    v_max3_f32 v254, v56, v57, v58
    v_max3_f32 v254, v254, v59, v68
    v_max3_f32 v254, v254, v69, v70
    v_max3_f32 v254, v254, v71, v80
    v_max3_f32 v254, v254, v81, v82
    v_max3_f32 v254, v254, v83, v92
    v_max3_f32 v254, v254, v93, v94
    v_max_f32 v254, v254, v95
    v_mov_b32 v255, v254
    s_nop 1
    v_permlane32_swap_b32 v254, v255
    v_max_f32 v254, v254, v255
    v_mov_b32 v255, v254
    s_nop 1
    v_permlane16_swap_b32 v254, v255
    v_max_f32 v254, v254, v255
    v_max_f32 v254, v254, v2
    v_sub_f32 v255, v2, v254
    v_mul_f32 v255, s24, v255
    v_exp_f32 v248, v255
    v_mov_b32 v2, v254
    v_mul_f32 v236, -v254, s24
    v_mul_f32 v239, v239, v248
    v_max3_f32 v254, v60, v61, v62
    v_max3_f32 v254, v254, v63, v72
    v_max3_f32 v254, v254, v73, v74
    v_max3_f32 v254, v254, v75, v84
    v_max3_f32 v254, v254, v85, v86
    v_max3_f32 v254, v254, v87, v96
    v_max3_f32 v254, v254, v97, v98
    v_max_f32 v254, v254, v99
    v_mov_b32 v255, v254
    s_nop 1
    v_permlane32_swap_b32 v254, v255
    v_max_f32 v254, v254, v255
    v_mov_b32 v255, v254
    s_nop 1
    v_permlane16_swap_b32 v254, v255
    v_max_f32 v254, v254, v255
    v_max_f32 v254, v254, v3
    v_sub_f32 v255, v3, v254
    v_mul_f32 v255, s24, v255
    v_exp_f32 v249, v255
    v_mov_b32 v3, v254
    v_mul_f32 v237, -v254, s24
    v_mul_f32 v240, v240, v249
    v_max3_f32 v254, v64, v65, v66
    v_max3_f32 v254, v254, v67, v76
    v_max3_f32 v254, v254, v77, v78
    v_max3_f32 v254, v254, v79, v88
    v_max3_f32 v254, v254, v89, v90
    v_max3_f32 v254, v254, v91, v100
    v_max3_f32 v254, v254, v101, v102
    v_max_f32 v254, v254, v103
    v_mov_b32 v255, v254
    s_nop 1
    v_permlane32_swap_b32 v254, v255
    v_max_f32 v254, v254, v255
    v_mov_b32 v255, v254
    s_nop 1
    v_permlane16_swap_b32 v254, v255
    v_max_f32 v254, v254, v255
    v_max_f32 v254, v254, v4
    v_sub_f32 v255, v4, v254
    v_mul_f32 v255, s24, v255
    v_exp_f32 v250, v255
    v_mov_b32 v4, v254
    v_mul_f32 v238, -v254, s24
    v_mul_f32 v241, v241, v250
    v_accvgpr_read_b32 v254, a0
    v_accvgpr_read_b32 v255, a1
    v_accvgpr_read_b32 v1, a2
    v_accvgpr_read_b32 v5, a3
    v_mul_f32 v254, v254, v248
    v_mul_f32 v255, v255, v248
    v_mul_f32 v1, v1, v248
    v_mul_f32 v5, v5, v248
    v_accvgpr_write_b32 a0, v254
    v_accvgpr_write_b32 a1, v255
    v_accvgpr_write_b32 a2, v1
    v_accvgpr_write_b32 a3, v5
    v_accvgpr_read_b32 v254, a4
    v_accvgpr_read_b32 v255, a5
    v_accvgpr_read_b32 v1, a6
    v_accvgpr_read_b32 v5, a7
    v_mul_f32 v254, v254, v249
    v_mul_f32 v255, v255, v249
    v_mul_f32 v1, v1, v249
    v_mul_f32 v5, v5, v249
    v_accvgpr_write_b32 a4, v254
    v_accvgpr_write_b32 a5, v255
    v_accvgpr_write_b32 a6, v1
    v_accvgpr_write_b32 a7, v5
    v_accvgpr_read_b32 v254, a8
    v_accvgpr_read_b32 v255, a9
    v_accvgpr_read_b32 v1, a10
    v_accvgpr_read_b32 v5, a11
    v_mul_f32 v254, v254, v250
    v_mul_f32 v255, v255, v250
    v_mul_f32 v1, v1, v250
    v_mul_f32 v5, v5, v250
    v_accvgpr_write_b32 a8, v254
    v_accvgpr_write_b32 a9, v255
    v_accvgpr_write_b32 a10, v1
    v_accvgpr_write_b32 a11, v5
    v_accvgpr_read_b32 v254, a12
    v_accvgpr_read_b32 v255, a13
    v_accvgpr_read_b32 v1, a14
    v_accvgpr_read_b32 v5, a15
    v_mul_f32 v254, v254, v248
    v_mul_f32 v255, v255, v248
    v_mul_f32 v1, v1, v248
    v_mul_f32 v5, v5, v248
    v_accvgpr_write_b32 a12, v254
    v_accvgpr_write_b32 a13, v255
    v_accvgpr_write_b32 a14, v1
    v_accvgpr_write_b32 a15, v5
    v_accvgpr_read_b32 v254, a16
    v_accvgpr_read_b32 v255, a17
    v_accvgpr_read_b32 v1, a18
    v_accvgpr_read_b32 v5, a19
    v_mul_f32 v254, v254, v249
    v_mul_f32 v255, v255, v249
    v_mul_f32 v1, v1, v249
    v_mul_f32 v5, v5, v249
    v_accvgpr_write_b32 a16, v254
    v_accvgpr_write_b32 a17, v255
    v_accvgpr_write_b32 a18, v1
    v_accvgpr_write_b32 a19, v5
    v_accvgpr_read_b32 v254, a20
    v_accvgpr_read_b32 v255, a21
    v_accvgpr_read_b32 v1, a22
    v_accvgpr_read_b32 v5, a23
    v_mul_f32 v254, v254, v250
    v_mul_f32 v255, v255, v250
    v_mul_f32 v1, v1, v250
    v_mul_f32 v5, v5, v250
    v_accvgpr_write_b32 a20, v254
    v_accvgpr_write_b32 a21, v255
    v_accvgpr_write_b32 a22, v1
    v_accvgpr_write_b32 a23, v5
    v_accvgpr_read_b32 v254, a24
    v_accvgpr_read_b32 v255, a25
    v_accvgpr_read_b32 v1, a26
    v_accvgpr_read_b32 v5, a27
    v_mul_f32 v254, v254, v248
    v_mul_f32 v255, v255, v248
    v_mul_f32 v1, v1, v248
    v_mul_f32 v5, v5, v248
    v_accvgpr_write_b32 a24, v254
    v_accvgpr_write_b32 a25, v255
    v_accvgpr_write_b32 a26, v1
    v_accvgpr_write_b32 a27, v5
    v_accvgpr_read_b32 v254, a28
    v_accvgpr_read_b32 v255, a29
    v_accvgpr_read_b32 v1, a30
    v_accvgpr_read_b32 v5, a31
    v_mul_f32 v254, v254, v249
    v_mul_f32 v255, v255, v249
    v_mul_f32 v1, v1, v249
    v_mul_f32 v5, v5, v249
    v_accvgpr_write_b32 a28, v254
    v_accvgpr_write_b32 a29, v255
    v_accvgpr_write_b32 a30, v1
    v_accvgpr_write_b32 a31, v5
    v_accvgpr_read_b32 v254, a32
    v_accvgpr_read_b32 v255, a33
    v_accvgpr_read_b32 v1, a34
    v_accvgpr_read_b32 v5, a35
    v_mul_f32 v254, v254, v250
    v_mul_f32 v255, v255, v250
    v_mul_f32 v1, v1, v250
    v_mul_f32 v5, v5, v250
    v_accvgpr_write_b32 a32, v254
    v_accvgpr_write_b32 a33, v255
    v_accvgpr_write_b32 a34, v1
    v_accvgpr_write_b32 a35, v5
    v_accvgpr_read_b32 v254, a36
    v_accvgpr_read_b32 v255, a37
    v_accvgpr_read_b32 v1, a38
    v_accvgpr_read_b32 v5, a39
    v_mul_f32 v254, v254, v248
    v_mul_f32 v255, v255, v248
    v_mul_f32 v1, v1, v248
    v_mul_f32 v5, v5, v248
    v_accvgpr_write_b32 a36, v254
    v_accvgpr_write_b32 a37, v255
    v_accvgpr_write_b32 a38, v1
    v_accvgpr_write_b32 a39, v5
    v_accvgpr_read_b32 v254, a40
    v_accvgpr_read_b32 v255, a41
    v_accvgpr_read_b32 v1, a42
    v_accvgpr_read_b32 v5, a43
    v_mul_f32 v254, v254, v249
    v_mul_f32 v255, v255, v249
    v_mul_f32 v1, v1, v249
    v_mul_f32 v5, v5, v249
    v_accvgpr_write_b32 a40, v254
    v_accvgpr_write_b32 a41, v255
    v_accvgpr_write_b32 a42, v1
    v_accvgpr_write_b32 a43, v5
    v_accvgpr_read_b32 v254, a44
    v_accvgpr_read_b32 v255, a45
    v_accvgpr_read_b32 v1, a46
    v_accvgpr_read_b32 v5, a47
    v_mul_f32 v254, v254, v250
    v_mul_f32 v255, v255, v250
    v_mul_f32 v1, v1, v250
    v_mul_f32 v5, v5, v250
    v_accvgpr_write_b32 a44, v254
    v_accvgpr_write_b32 a45, v255
    v_accvgpr_write_b32 a46, v1
    v_accvgpr_write_b32 a47, v5
    v_accvgpr_read_b32 v254, a48
    v_accvgpr_read_b32 v255, a49
    v_accvgpr_read_b32 v1, a50
    v_accvgpr_read_b32 v5, a51
    v_mul_f32 v254, v254, v248
    v_mul_f32 v255, v255, v248
    v_mul_f32 v1, v1, v248
    v_mul_f32 v5, v5, v248
    v_accvgpr_write_b32 a48, v254
    v_accvgpr_write_b32 a49, v255
    v_accvgpr_write_b32 a50, v1
    v_accvgpr_write_b32 a51, v5
    v_accvgpr_read_b32 v254, a52
    v_accvgpr_read_b32 v255, a53
    v_accvgpr_read_b32 v1, a54
    v_accvgpr_read_b32 v5, a55
    v_mul_f32 v254, v254, v249
    v_mul_f32 v255, v255, v249
    v_mul_f32 v1, v1, v249
    v_mul_f32 v5, v5, v249
    v_accvgpr_write_b32 a52, v254
    v_accvgpr_write_b32 a53, v255
    v_accvgpr_write_b32 a54, v1
    v_accvgpr_write_b32 a55, v5
    v_accvgpr_read_b32 v254, a56
    v_accvgpr_read_b32 v255, a57
    v_accvgpr_read_b32 v1, a58
    v_accvgpr_read_b32 v5, a59
    v_mul_f32 v254, v254, v250
    v_mul_f32 v255, v255, v250
    v_mul_f32 v1, v1, v250
    v_mul_f32 v5, v5, v250
    v_accvgpr_write_b32 a56, v254
    v_accvgpr_write_b32 a57, v255
    v_accvgpr_write_b32 a58, v1
    v_accvgpr_write_b32 a59, v5
    v_accvgpr_read_b32 v254, a60
    v_accvgpr_read_b32 v255, a61
    v_accvgpr_read_b32 v1, a62
    v_accvgpr_read_b32 v5, a63
    v_mul_f32 v254, v254, v248
    v_mul_f32 v255, v255, v248
    v_mul_f32 v1, v1, v248
    v_mul_f32 v5, v5, v248
    v_accvgpr_write_b32 a60, v254
    v_accvgpr_write_b32 a61, v255
    v_accvgpr_write_b32 a62, v1
    v_accvgpr_write_b32 a63, v5
    v_accvgpr_read_b32 v254, a64
    v_accvgpr_read_b32 v255, a65
    v_accvgpr_read_b32 v1, a66
    v_accvgpr_read_b32 v5, a67
    v_mul_f32 v254, v254, v249
    v_mul_f32 v255, v255, v249
    v_mul_f32 v1, v1, v249
    v_mul_f32 v5, v5, v249
    v_accvgpr_write_b32 a64, v254
    v_accvgpr_write_b32 a65, v255
    v_accvgpr_write_b32 a66, v1
    v_accvgpr_write_b32 a67, v5
    v_accvgpr_read_b32 v254, a68
    v_accvgpr_read_b32 v255, a69
    v_accvgpr_read_b32 v1, a70
    v_accvgpr_read_b32 v5, a71
    v_mul_f32 v254, v254, v250
    v_mul_f32 v255, v255, v250
    v_mul_f32 v1, v1, v250
    v_mul_f32 v5, v5, v250
    v_accvgpr_write_b32 a68, v254
    v_accvgpr_write_b32 a69, v255
    v_accvgpr_write_b32 a70, v1
    v_accvgpr_write_b32 a71, v5
    v_accvgpr_read_b32 v254, a72
    v_accvgpr_read_b32 v255, a73
    v_accvgpr_read_b32 v1, a74
    v_accvgpr_read_b32 v5, a75
    v_mul_f32 v254, v254, v248
    v_mul_f32 v255, v255, v248
    v_mul_f32 v1, v1, v248
    v_mul_f32 v5, v5, v248
    v_accvgpr_write_b32 a72, v254
    v_accvgpr_write_b32 a73, v255
    v_accvgpr_write_b32 a74, v1
    v_accvgpr_write_b32 a75, v5
    v_accvgpr_read_b32 v254, a76
    v_accvgpr_read_b32 v255, a77
    v_accvgpr_read_b32 v1, a78
    v_accvgpr_read_b32 v5, a79
    v_mul_f32 v254, v254, v249
    v_mul_f32 v255, v255, v249
    v_mul_f32 v1, v1, v249
    v_mul_f32 v5, v5, v249
    v_accvgpr_write_b32 a76, v254
    v_accvgpr_write_b32 a77, v255
    v_accvgpr_write_b32 a78, v1
    v_accvgpr_write_b32 a79, v5
    v_accvgpr_read_b32 v254, a80
    v_accvgpr_read_b32 v255, a81
    v_accvgpr_read_b32 v1, a82
    v_accvgpr_read_b32 v5, a83
    v_mul_f32 v254, v254, v250
    v_mul_f32 v255, v255, v250
    v_mul_f32 v1, v1, v250
    v_mul_f32 v5, v5, v250
    v_accvgpr_write_b32 a80, v254
    v_accvgpr_write_b32 a81, v255
    v_accvgpr_write_b32 a82, v1
    v_accvgpr_write_b32 a83, v5
    v_accvgpr_read_b32 v254, a84
    v_accvgpr_read_b32 v255, a85
    v_accvgpr_read_b32 v1, a86
    v_accvgpr_read_b32 v5, a87
    v_mul_f32 v254, v254, v248
    v_mul_f32 v255, v255, v248
    v_mul_f32 v1, v1, v248
    v_mul_f32 v5, v5, v248
    v_accvgpr_write_b32 a84, v254
    v_accvgpr_write_b32 a85, v255
    v_accvgpr_write_b32 a86, v1
    v_accvgpr_write_b32 a87, v5
    v_accvgpr_read_b32 v254, a88
    v_accvgpr_read_b32 v255, a89
    v_accvgpr_read_b32 v1, a90
    v_accvgpr_read_b32 v5, a91
    v_mul_f32 v254, v254, v249
    v_mul_f32 v255, v255, v249
    v_mul_f32 v1, v1, v249
    v_mul_f32 v5, v5, v249
    v_accvgpr_write_b32 a88, v254
    v_accvgpr_write_b32 a89, v255
    v_accvgpr_write_b32 a90, v1
    v_accvgpr_write_b32 a91, v5
    v_accvgpr_read_b32 v254, a92
    v_accvgpr_read_b32 v255, a93
    v_accvgpr_read_b32 v1, a94
    v_accvgpr_read_b32 v5, a95
    v_mul_f32 v254, v254, v250
    v_mul_f32 v255, v255, v250
    v_mul_f32 v1, v1, v250
    v_mul_f32 v5, v5, v250
    v_accvgpr_write_b32 a92, v254
    v_accvgpr_write_b32 a93, v255
    v_accvgpr_write_b32 a94, v1
    v_accvgpr_write_b32 a95, v5
    v_accvgpr_read_b32 v254, a96
    v_accvgpr_read_b32 v255, a97
    v_accvgpr_read_b32 v1, a98
    v_accvgpr_read_b32 v5, a99
    v_mul_f32 v254, v254, v248
    v_mul_f32 v255, v255, v248
    v_mul_f32 v1, v1, v248
    v_mul_f32 v5, v5, v248
    v_accvgpr_write_b32 a96, v254
    v_accvgpr_write_b32 a97, v255
    v_accvgpr_write_b32 a98, v1
    v_accvgpr_write_b32 a99, v5
    v_accvgpr_read_b32 v254, a100
    v_accvgpr_read_b32 v255, a101
    v_accvgpr_read_b32 v1, a102
    v_accvgpr_read_b32 v5, a103
    v_mul_f32 v254, v254, v249
    v_mul_f32 v255, v255, v249
    v_mul_f32 v1, v1, v249
    v_mul_f32 v5, v5, v249
    v_accvgpr_write_b32 a100, v254
    v_accvgpr_write_b32 a101, v255
    v_accvgpr_write_b32 a102, v1
    v_accvgpr_write_b32 a103, v5
    v_accvgpr_read_b32 v254, a104
    v_accvgpr_read_b32 v255, a105
    v_accvgpr_read_b32 v1, a106
    v_accvgpr_read_b32 v5, a107
    v_mul_f32 v254, v254, v250
    v_mul_f32 v255, v255, v250
    v_mul_f32 v1, v1, v250
    v_mul_f32 v5, v5, v250
    v_accvgpr_write_b32 a104, v254
    v_accvgpr_write_b32 a105, v255
    v_accvgpr_write_b32 a106, v1
    v_accvgpr_write_b32 a107, v5
    v_accvgpr_read_b32 v254, a108
    v_accvgpr_read_b32 v255, a109
    v_accvgpr_read_b32 v1, a110
    v_accvgpr_read_b32 v5, a111
    v_mul_f32 v254, v254, v248
    v_mul_f32 v255, v255, v248
    v_mul_f32 v1, v1, v248
    v_mul_f32 v5, v5, v248
    v_accvgpr_write_b32 a108, v254
    v_accvgpr_write_b32 a109, v255
    v_accvgpr_write_b32 a110, v1
    v_accvgpr_write_b32 a111, v5
    v_accvgpr_read_b32 v254, a112
    v_accvgpr_read_b32 v255, a113
    v_accvgpr_read_b32 v1, a114
    v_accvgpr_read_b32 v5, a115
    v_mul_f32 v254, v254, v249
    v_mul_f32 v255, v255, v249
    v_mul_f32 v1, v1, v249
    v_mul_f32 v5, v5, v249
    v_accvgpr_write_b32 a112, v254
    v_accvgpr_write_b32 a113, v255
    v_accvgpr_write_b32 a114, v1
    v_accvgpr_write_b32 a115, v5
    v_accvgpr_read_b32 v254, a116
    v_accvgpr_read_b32 v255, a117
    v_accvgpr_read_b32 v1, a118
    v_accvgpr_read_b32 v5, a119
    v_mul_f32 v254, v254, v250
    v_mul_f32 v255, v255, v250
    v_mul_f32 v1, v1, v250
    v_mul_f32 v5, v5, v250
    v_accvgpr_write_b32 a116, v254
    v_accvgpr_write_b32 a117, v255
    v_accvgpr_write_b32 a118, v1
    v_accvgpr_write_b32 a119, v5
    v_accvgpr_read_b32 v254, a120
    v_accvgpr_read_b32 v255, a121
    v_accvgpr_read_b32 v1, a122
    v_accvgpr_read_b32 v5, a123
    v_mul_f32 v254, v254, v248
    v_mul_f32 v255, v255, v248
    v_mul_f32 v1, v1, v248
    v_mul_f32 v5, v5, v248
    v_accvgpr_write_b32 a120, v254
    v_accvgpr_write_b32 a121, v255
    v_accvgpr_write_b32 a122, v1
    v_accvgpr_write_b32 a123, v5
    v_accvgpr_read_b32 v254, a124
    v_accvgpr_read_b32 v255, a125
    v_accvgpr_read_b32 v1, a126
    v_accvgpr_read_b32 v5, a127
    v_mul_f32 v254, v254, v249
    v_mul_f32 v255, v255, v249
    v_mul_f32 v1, v1, v249
    v_mul_f32 v5, v5, v249
    v_accvgpr_write_b32 a124, v254
    v_accvgpr_write_b32 a125, v255
    v_accvgpr_write_b32 a126, v1
    v_accvgpr_write_b32 a127, v5
    v_accvgpr_read_b32 v254, a128
    v_accvgpr_read_b32 v255, a129
    v_accvgpr_read_b32 v1, a130
    v_accvgpr_read_b32 v5, a131
    v_mul_f32 v254, v254, v250
    v_mul_f32 v255, v255, v250
    v_mul_f32 v1, v1, v250
    v_mul_f32 v5, v5, v250
    v_accvgpr_write_b32 a128, v254
    v_accvgpr_write_b32 a129, v255
    v_accvgpr_write_b32 a130, v1
    v_accvgpr_write_b32 a131, v5
    v_accvgpr_read_b32 v254, a132
    v_accvgpr_read_b32 v255, a133
    v_accvgpr_read_b32 v1, a134
    v_accvgpr_read_b32 v5, a135
    v_mul_f32 v254, v254, v248
    v_mul_f32 v255, v255, v248
    v_mul_f32 v1, v1, v248
    v_mul_f32 v5, v5, v248
    v_accvgpr_write_b32 a132, v254
    v_accvgpr_write_b32 a133, v255
    v_accvgpr_write_b32 a134, v1
    v_accvgpr_write_b32 a135, v5
    v_accvgpr_read_b32 v254, a136
    v_accvgpr_read_b32 v255, a137
    v_accvgpr_read_b32 v1, a138
    v_accvgpr_read_b32 v5, a139
    v_mul_f32 v254, v254, v249
    v_mul_f32 v255, v255, v249
    v_mul_f32 v1, v1, v249
    v_mul_f32 v5, v5, v249
    v_accvgpr_write_b32 a136, v254
    v_accvgpr_write_b32 a137, v255
    v_accvgpr_write_b32 a138, v1
    v_accvgpr_write_b32 a139, v5
    v_accvgpr_read_b32 v254, a140
    v_accvgpr_read_b32 v255, a141
    v_accvgpr_read_b32 v1, a142
    v_accvgpr_read_b32 v5, a143
    v_mul_f32 v254, v254, v250
    v_mul_f32 v255, v255, v250
    v_mul_f32 v1, v1, v250
    v_mul_f32 v5, v5, v250
    v_accvgpr_write_b32 a140, v254
    v_accvgpr_write_b32 a141, v255
    v_accvgpr_write_b32 a142, v1
    v_accvgpr_write_b32 a143, v5
    v_accvgpr_read_b32 v254, a144
    v_accvgpr_read_b32 v255, a145
    v_accvgpr_read_b32 v1, a146
    v_accvgpr_read_b32 v5, a147
    v_mul_f32 v254, v254, v248
    v_mul_f32 v255, v255, v248
    v_mul_f32 v1, v1, v248
    v_mul_f32 v5, v5, v248
    v_accvgpr_write_b32 a144, v254
    v_accvgpr_write_b32 a145, v255
    v_accvgpr_write_b32 a146, v1
    v_accvgpr_write_b32 a147, v5
    v_accvgpr_read_b32 v254, a148
    v_accvgpr_read_b32 v255, a149
    v_accvgpr_read_b32 v1, a150
    v_accvgpr_read_b32 v5, a151
    v_mul_f32 v254, v254, v249
    v_mul_f32 v255, v255, v249
    v_mul_f32 v1, v1, v249
    v_mul_f32 v5, v5, v249
    v_accvgpr_write_b32 a148, v254
    v_accvgpr_write_b32 a149, v255
    v_accvgpr_write_b32 a150, v1
    v_accvgpr_write_b32 a151, v5
    v_accvgpr_read_b32 v254, a152
    v_accvgpr_read_b32 v255, a153
    v_accvgpr_read_b32 v1, a154
    v_accvgpr_read_b32 v5, a155
    v_mul_f32 v254, v254, v250
    v_mul_f32 v255, v255, v250
    v_mul_f32 v1, v1, v250
    v_mul_f32 v5, v5, v250
    v_accvgpr_write_b32 a152, v254
    v_accvgpr_write_b32 a153, v255
    v_accvgpr_write_b32 a154, v1
    v_accvgpr_write_b32 a155, v5
    v_accvgpr_read_b32 v254, a156
    v_accvgpr_read_b32 v255, a157
    v_accvgpr_read_b32 v1, a158
    v_accvgpr_read_b32 v5, a159
    v_mul_f32 v254, v254, v248
    v_mul_f32 v255, v255, v248
    v_mul_f32 v1, v1, v248
    v_mul_f32 v5, v5, v248
    v_accvgpr_write_b32 a156, v254
    v_accvgpr_write_b32 a157, v255
    v_accvgpr_write_b32 a158, v1
    v_accvgpr_write_b32 a159, v5
    v_accvgpr_read_b32 v254, a160
    v_accvgpr_read_b32 v255, a161
    v_accvgpr_read_b32 v1, a162
    v_accvgpr_read_b32 v5, a163
    v_mul_f32 v254, v254, v249
    v_mul_f32 v255, v255, v249
    v_mul_f32 v1, v1, v249
    v_mul_f32 v5, v5, v249
    v_accvgpr_write_b32 a160, v254
    v_accvgpr_write_b32 a161, v255
    v_accvgpr_write_b32 a162, v1
    v_accvgpr_write_b32 a163, v5
    v_accvgpr_read_b32 v254, a164
    v_accvgpr_read_b32 v255, a165
    v_accvgpr_read_b32 v1, a166
    v_accvgpr_read_b32 v5, a167
    v_mul_f32 v254, v254, v250
    v_mul_f32 v255, v255, v250
    v_mul_f32 v1, v1, v250
    v_mul_f32 v5, v5, v250
    v_accvgpr_write_b32 a164, v254
    v_accvgpr_write_b32 a165, v255
    v_accvgpr_write_b32 a166, v1
    v_accvgpr_write_b32 a167, v5
    v_accvgpr_read_b32 v254, a168
    v_accvgpr_read_b32 v255, a169
    v_accvgpr_read_b32 v1, a170
    v_accvgpr_read_b32 v5, a171
    v_mul_f32 v254, v254, v248
    v_mul_f32 v255, v255, v248
    v_mul_f32 v1, v1, v248
    v_mul_f32 v5, v5, v248
    v_accvgpr_write_b32 a168, v254
    v_accvgpr_write_b32 a169, v255
    v_accvgpr_write_b32 a170, v1
    v_accvgpr_write_b32 a171, v5
    v_accvgpr_read_b32 v254, a172
    v_accvgpr_read_b32 v255, a173
    v_accvgpr_read_b32 v1, a174
    v_accvgpr_read_b32 v5, a175
    v_mul_f32 v254, v254, v249
    v_mul_f32 v255, v255, v249
    v_mul_f32 v1, v1, v249
    v_mul_f32 v5, v5, v249
    v_accvgpr_write_b32 a172, v254
    v_accvgpr_write_b32 a173, v255
    v_accvgpr_write_b32 a174, v1
    v_accvgpr_write_b32 a175, v5
    v_accvgpr_read_b32 v254, a176
    v_accvgpr_read_b32 v255, a177
    v_accvgpr_read_b32 v1, a178
    v_accvgpr_read_b32 v5, a179
    v_mul_f32 v254, v254, v250
    v_mul_f32 v255, v255, v250
    v_mul_f32 v1, v1, v250
    v_mul_f32 v5, v5, v250
    v_accvgpr_write_b32 a176, v254
    v_accvgpr_write_b32 a177, v255
    v_accvgpr_write_b32 a178, v1
    v_accvgpr_write_b32 a179, v5
    v_accvgpr_read_b32 v254, a180
    v_accvgpr_read_b32 v255, a181
    v_accvgpr_read_b32 v1, a182
    v_accvgpr_read_b32 v5, a183
    v_mul_f32 v254, v254, v248
    v_mul_f32 v255, v255, v248
    v_mul_f32 v1, v1, v248
    v_mul_f32 v5, v5, v248
    v_accvgpr_write_b32 a180, v254
    v_accvgpr_write_b32 a181, v255
    v_accvgpr_write_b32 a182, v1
    v_accvgpr_write_b32 a183, v5
    v_accvgpr_read_b32 v254, a184
    v_accvgpr_read_b32 v255, a185
    v_accvgpr_read_b32 v1, a186
    v_accvgpr_read_b32 v5, a187
    v_mul_f32 v254, v254, v249
    v_mul_f32 v255, v255, v249
    v_mul_f32 v1, v1, v249
    v_mul_f32 v5, v5, v249
    v_accvgpr_write_b32 a184, v254
    v_accvgpr_write_b32 a185, v255
    v_accvgpr_write_b32 a186, v1
    v_accvgpr_write_b32 a187, v5
    v_accvgpr_read_b32 v254, a188
    v_accvgpr_read_b32 v255, a189
    v_accvgpr_read_b32 v1, a190
    v_accvgpr_read_b32 v5, a191
    v_mul_f32 v254, v254, v250
    v_mul_f32 v255, v255, v250
    v_mul_f32 v1, v1, v250
    v_mul_f32 v5, v5, v250
    v_accvgpr_write_b32 a188, v254
    v_accvgpr_write_b32 a189, v255
    v_accvgpr_write_b32 a190, v1
    v_accvgpr_write_b32 a191, v5
    v_fma_f32 v248, v56, s24, v236
    v_fma_f32 v249, v57, s24, v236
    v_fma_f32 v250, v58, s24, v236
    v_fma_f32 v251, v59, s24, v236
    v_exp_f32 v248, v248
    v_exp_f32 v249, v249
    v_fma_f32 v252, v60, s24, v237
    v_fma_f32 v253, v61, s24, v237
    v_exp_f32 v250, v250
    v_exp_f32 v251, v251
    v_add_f32 v242, v248, v249
    v_cvt_pk_bf16_f32 v128, v248, v249
    v_fma_f32 v248, v62, s24, v237
    v_fma_f32 v249, v63, s24, v237
    v_exp_f32 v252, v252
    v_exp_f32 v253, v253
    v_add_f32 v242, v242, v250
    v_add_f32 v242, v242, v251
    v_cvt_pk_bf16_f32 v129, v250, v251
    v_fma_f32 v250, v64, s24, v238
    v_fma_f32 v251, v65, s24, v238
    v_exp_f32 v248, v248
    v_exp_f32 v249, v249
    v_add_f32 v243, v252, v253
    v_cvt_pk_bf16_f32 v132, v252, v253
    v_fma_f32 v252, v66, s24, v238
    v_fma_f32 v253, v67, s24, v238
    v_exp_f32 v250, v250
    v_exp_f32 v251, v251
    v_add_f32 v243, v243, v248
    v_add_f32 v243, v243, v249
    v_cvt_pk_bf16_f32 v133, v248, v249
    v_fma_f32 v248, v68, s24, v236
    v_fma_f32 v249, v69, s24, v236
    v_exp_f32 v252, v252
    v_exp_f32 v253, v253
    v_add_f32 v244, v250, v251
    v_cvt_pk_bf16_f32 v136, v250, v251
    v_fma_f32 v250, v70, s24, v236
    v_fma_f32 v251, v71, s24, v236
    v_exp_f32 v248, v248
    v_exp_f32 v249, v249
    v_add_f32 v244, v244, v252
    v_add_f32 v244, v244, v253
    v_cvt_pk_bf16_f32 v137, v252, v253
    v_fma_f32 v252, v72, s24, v237
    v_fma_f32 v253, v73, s24, v237
    v_exp_f32 v250, v250
    v_exp_f32 v251, v251
    v_add_f32 v242, v242, v248
    v_add_f32 v242, v242, v249
    v_cvt_pk_bf16_f32 v130, v248, v249
    v_fma_f32 v248, v74, s24, v237
    v_fma_f32 v249, v75, s24, v237
    v_exp_f32 v252, v252
    v_exp_f32 v253, v253
    v_add_f32 v242, v242, v250
    v_add_f32 v242, v242, v251
    v_cvt_pk_bf16_f32 v131, v250, v251
    v_fma_f32 v250, v76, s24, v238
    v_fma_f32 v251, v77, s24, v238
    v_exp_f32 v248, v248
    v_exp_f32 v249, v249
    v_add_f32 v243, v243, v252
    v_add_f32 v243, v243, v253
    v_cvt_pk_bf16_f32 v134, v252, v253
    v_fma_f32 v252, v78, s24, v238
    v_fma_f32 v253, v79, s24, v238
    v_exp_f32 v250, v250
    v_exp_f32 v251, v251
    v_add_f32 v243, v243, v248
    v_add_f32 v243, v243, v249
    v_cvt_pk_bf16_f32 v135, v248, v249
    v_exp_f32 v252, v252
    v_exp_f32 v253, v253
    v_add_f32 v244, v244, v250
    v_add_f32 v244, v244, v251
    v_cvt_pk_bf16_f32 v138, v250, v251
    v_add_f32 v244, v244, v252
    v_add_f32 v244, v244, v253
    v_cvt_pk_bf16_f32 v139, v252, v253
    v_fma_f32 v248, v80, s24, v236
    v_fma_f32 v249, v81, s24, v236
    v_fma_f32 v250, v82, s24, v236
    v_fma_f32 v251, v83, s24, v236
    v_exp_f32 v248, v248
    v_exp_f32 v249, v249
    v_fma_f32 v252, v84, s24, v237
    v_fma_f32 v253, v85, s24, v237
    v_exp_f32 v250, v250
    v_exp_f32 v251, v251
    v_add_f32 v245, v248, v249
    v_cvt_pk_bf16_f32 v140, v248, v249
    v_fma_f32 v248, v86, s24, v237
    v_fma_f32 v249, v87, s24, v237
    v_exp_f32 v252, v252
    v_exp_f32 v253, v253
    v_add_f32 v245, v245, v250
    v_add_f32 v245, v245, v251
    v_cvt_pk_bf16_f32 v141, v250, v251
    v_fma_f32 v250, v88, s24, v238
    v_fma_f32 v251, v89, s24, v238
    v_exp_f32 v248, v248
    v_exp_f32 v249, v249
    v_add_f32 v246, v252, v253
    v_cvt_pk_bf16_f32 v144, v252, v253
    v_fma_f32 v252, v90, s24, v238
    v_fma_f32 v253, v91, s24, v238
    v_exp_f32 v250, v250
    v_exp_f32 v251, v251
    v_add_f32 v246, v246, v248
    v_add_f32 v246, v246, v249
    v_cvt_pk_bf16_f32 v145, v248, v249
    v_fma_f32 v248, v92, s24, v236
    v_fma_f32 v249, v93, s24, v236
    v_exp_f32 v252, v252
    v_exp_f32 v253, v253
    v_add_f32 v247, v250, v251
    v_cvt_pk_bf16_f32 v148, v250, v251
    v_fma_f32 v250, v94, s24, v236
    v_fma_f32 v251, v95, s24, v236
    v_exp_f32 v248, v248
    v_exp_f32 v249, v249
    v_add_f32 v247, v247, v252
    v_add_f32 v247, v247, v253
    v_cvt_pk_bf16_f32 v149, v252, v253
    v_fma_f32 v252, v96, s24, v237
    v_fma_f32 v253, v97, s24, v237
    v_exp_f32 v250, v250
    v_exp_f32 v251, v251
    v_add_f32 v245, v245, v248
    v_add_f32 v245, v245, v249
    v_cvt_pk_bf16_f32 v142, v248, v249
    v_fma_f32 v248, v98, s24, v237
    v_fma_f32 v249, v99, s24, v237
    v_exp_f32 v252, v252
    v_exp_f32 v253, v253
    v_add_f32 v245, v245, v250
    v_add_f32 v245, v245, v251
    v_cvt_pk_bf16_f32 v143, v250, v251
    v_fma_f32 v250, v100, s24, v238
    v_fma_f32 v251, v101, s24, v238
    v_exp_f32 v248, v248
    v_exp_f32 v249, v249
    v_add_f32 v246, v246, v252
    v_add_f32 v246, v246, v253
    v_cvt_pk_bf16_f32 v146, v252, v253
    v_fma_f32 v252, v102, s24, v238
    v_fma_f32 v253, v103, s24, v238
    v_exp_f32 v250, v250
    v_exp_f32 v251, v251
    v_add_f32 v246, v246, v248
    v_add_f32 v246, v246, v249
    v_cvt_pk_bf16_f32 v147, v248, v249
    v_exp_f32 v252, v252
    v_exp_f32 v253, v253
    v_add_f32 v247, v247, v250
    v_add_f32 v247, v247, v251
    v_cvt_pk_bf16_f32 v150, v250, v251
    v_add_f32 v247, v247, v252
    v_add_f32 v247, v247, v253
    v_cvt_pk_bf16_f32 v151, v252, v253
    v_add_f32 v254, v242, v245
    v_add_f32 v255, v243, v246
    v_add_f32 v1, v244, v247
    s_branch L_back_t1
L_end:
    s_endpgm
.section .rodata,"a"
.p2align 6
.amdhsa_kernel standalone__mha_softmax__near_ridge_kernel
  .amdhsa_next_free_vgpr 512
  .amdhsa_next_free_sgpr 72
  .amdhsa_accum_offset 256
  .amdhsa_group_segment_fixed_size 0
  .amdhsa_kernarg_size 48
  .amdhsa_user_sgpr_count 2
  .amdhsa_user_sgpr_kernarg_segment_ptr 1
  .amdhsa_system_sgpr_workgroup_id_x 1
.end_amdhsa_kernel
```
